```python
import torch

def _softmax(x, axis=-1):
    return torch.softmax(x, dim=axis)

def _gelu(x):
    return torch.nn.functional.gelu(x, approximate='tanh')

def _silu(x):
    return torch.nn.functional.silu(x)

def _sigmoid(x):
    return torch.sigmoid(x)

def _layernorm(x, axis=-1, eps=1e-05):
    m = x.mean(dim=axis, keepdim=True)
    v = x.var(dim=axis, keepdim=True, unbiased=False)
    return (x - m) / torch.sqrt(v + eps)

def _scatter_add(tgt, idx, src, axis=0):
    return tgt.clone().index_add_(axis, idx, src)

def _segment_sum(src, seg, n):
    out = torch.zeros((n,) + src.shape[1:], dtype=src.dtype)
    return out.index_add_(0, seg, src)

def _pad(x, pw):
    flat = tuple((v for pair in reversed(pw) for v in pair))
    return torch.nn.functional.pad(x, flat)
kernel_name = 'adaLN_cond__sliding_block__dense_activation_relu__prompt'

def setup_inputs():

    _w = lambda a: (lambda t: t.to(torch.bfloat16) if t.is_floating_point() else t)(torch.as_tensor(a))

    def _A_setup():
        B, S, D = (1, 2048, 448)
        return {'x': _w((lambda *s: torch.randn(*s, dtype=torch.bfloat16) * 0.05)(B, S, D)), 'wqkv': _w((lambda *s: torch.randn(*s, dtype=torch.bfloat16) * 0.05)(D, 3 * D)), 'wo': _w((lambda *s: torch.randn(*s, dtype=torch.bfloat16) * 0.05)(D, D))}
    _A_in = _A_setup()

    def _B_setup():
        B, S, D, Dff = (1, 2048, 448, 1792)
        return {'x': _w((lambda *s: torch.randn(*s, dtype=torch.bfloat16) * 0.05)(B, S, D)), 'w1': _w((lambda *s: torch.randn(*s, dtype=torch.bfloat16) * 0.05)(D, Dff)), 'w2': _w((lambda *s: torch.randn(*s, dtype=torch.bfloat16) * 0.05)(Dff, D))}
    _B_in = _B_setup()
    return {'A_x': _A_in['x'], 'A_wqkv': _A_in['wqkv'], 'A_wo': _A_in['wo'], 'B_x': _B_in['x'], 'B_w1': _B_in['w1'], 'B_w2': _B_in['w2'], 'c': _w((lambda *s: torch.randn(*s, dtype=torch.bfloat16) * 0.1)(1, 448) * 8.0), 'w_mod': _w((lambda *s: torch.randn(*s, dtype=torch.bfloat16) * 0.1)(448, 6 * 448) * 448 ** (-0.5) * 8.0)}

def reference(A_x, A_wqkv, A_wo, B_x, B_w1, B_w2, c, w_mod):

    def _A_ref(x, wqkv, wo):
        B, S, D = x.shape
        H = 16
        Dh = D // H
        W = 256
        qkv = (lambda x, *d: x.permute(*d))((x @ wqkv).reshape(B, S, 3, H, Dh), 2, 0, 3, 1, 4)
        q, k, v = (qkv[0], qkv[1], qkv[2])
        scores = torch.einsum('bhqd,bhkd->bhqk', q, k) * Dh ** (-0.5)
        idx = torch.arange(S)
        mask = (idx[:, None] - idx[None, :] >= 0) & (idx[:, None] - idx[None, :] < W)
        scores = torch.where(mask[None, None], scores, -1000000000.0)
        p = _softmax(scores, axis=-1)
        o = torch.einsum('bhqk,bhkd->bhqd', p, v)
        return (lambda x, *d: x.permute(*d))(o, 0, 2, 1, 3).reshape(B, S, D) @ wo

    def _B_ref(x, w1, w2):
        h = torch.einsum('bsd,df->bsf', x, w1)
        zero = torch.zeros_like(h)
        h = torch.maximum(h, zero)
        return torch.einsum('bsf,fd->bsd', h, w2)
    x = A_x
    mod = (_silu(c) @ w_mod).reshape(c.shape[0], 6, 1, -1)
    sa, ca, ga, sb, cb, gb = (mod[:, 0].clone(), mod[:, 1].clone(), mod[:, 2].clone(), mod[:, 3].clone(), mod[:, 4].clone(), mod[:, 5].clone())
    h = _layernorm(x, axis=-1) * (1 + ca) + sa
    x = x + ga * _A_ref(h, A_wqkv, A_wo)
    h = _layernorm(x, axis=-1) * (1 + cb) + sb
    x = x + gb * _B_ref(h, B_w1, B_w2)
    return x
```

```asm
; @launch kernel=k1_kernel grid=(190,1,1) block=(256,1,1) lds=32768
; @launch kernel=k2_kernel grid=(249,1,1) block=(512,1,1) lds=65536
; @launch kernel=k3_kernel grid=(256,1,1) block=(512,1,1) lds=65536
; @launch kernel=k4_kernel grid=(224,1,1) block=(512,1,1) lds=131072
; @launch kernel=k5_kernel grid=(256,1,1) block=(512,1,1) lds=60928
; @launch kernel=k6_kernel grid=(224,1,1) block=(512,1,1) lds=163840
.amdgcn_target "amdgcn-amd-amdhsa--gfx950"
.text
    .globl k1_kernel
    .p2align 8
    .type k1_kernel,@function
k1_kernel:
    s_load_dwordx16 s[4:19], s[0:1], 0
    s_load_dwordx2 s[20:21], s[0:1], 80
    s_cmp_ge_u32 s2, 190
    s_cbranch_scc1 L_k1_exit
    s_waitcnt lgkmcnt(0)
    s_cmp_lt_u32 s2, 84
    s_cbranch_scc1 L_k1_mod
    s_cmp_lt_u32 s2, 148
    s_cbranch_scc1 L_k1_ln
L_k1_wqkv:
    s_mov_b32 s24, s6
    s_and_b32 s25, s7, 0xffff
    s_mov_b32 s26, 1204224
    s_mov_b32 s27, 0x00020000
    s_add_u32 s28, s20, 2097152
    s_addc_u32 s29, s21, 0
    s_and_b32 s29, s29, 0xffff
    s_mov_b32 s30, 1376256
    s_mov_b32 s31, 0x00020000
    v_lshrrev_b32 v1, 6, v0
    s_nop 0
    v_readfirstlane_b32 s37, v1
    s_sub_u32 s3, s2, 148
    s_lshl_b32 s3, s3, 2
    s_add_u32 s3, s3, s37
    s_cmp_ge_u32 s3, 168
    s_cbranch_scc1 L_prep_end_1
    s_mul_i32 s38, s3, 171
    s_lshr_b32 s38, s38, 12
    s_mul_i32 s39, s38, 24
    s_sub_u32 s39, s3, s39
    v_and_b32 v1, 63, v0
    v_lshrrev_b32 v2, 3, v1
    v_and_b32 v3, 7, v1
    s_lshl_b32 s40, s38, 3
    v_add_u32 v4, s40, v2
    v_mul_u32_u24 v4, 21504, v4
    s_lshl_b32 s40, s39, 3
    v_add_u32 v7, s40, v3
    v_lshrrev_b32 v5, 2, v7
    v_and_b32 v6, 3, v7
    v_mul_u32_u24 v5, 56, v5
    v_lshl_add_u32 v5, v6, 4, v5
    v_add_u32 v4, v4, v5
    s_mov_b32 s34, 0
    buffer_load_dwordx4 v[8:11], v4, s[24:27], s34 offen
    s_mov_b32 s34, 2688
    buffer_load_dwordx4 v[12:15], v4, s[24:27], s34 offen
    s_mov_b32 s34, 5376
    buffer_load_dwordx4 v[16:19], v4, s[24:27], s34 offen
    s_mov_b32 s34, 8064
    buffer_load_dwordx4 v[20:23], v4, s[24:27], s34 offen
    s_mov_b32 s34, 10752
    buffer_load_dwordx4 v[24:27], v4, s[24:27], s34 offen
    s_mov_b32 s34, 13440
    buffer_load_dwordx4 v[28:31], v4, s[24:27], s34 offen
    s_mov_b32 s34, 16128
    buffer_load_dwordx4 v[32:35], v4, s[24:27], s34 offen
    s_mov_b32 s34, 18816
    buffer_load_dwordx4 v[36:39], v4, s[24:27], s34 offen
    v_lshrrev_b32 v5, 2, v2
    v_lshlrev_b32 v5, 12, v5
    v_lshrrev_b32 v7, 1, v3
    v_lshl_add_u32 v5, v7, 10, v5
    v_and_b32 v7, 3, v2
    v_lshl_add_u32 v5, v7, 8, v5
    v_and_b32 v7, 1, v3
    v_lshl_add_u32 v5, v7, 7, v5
    s_lshl_b32 s40, s37, 13
    v_add_u32 v5, s40, v5
    v_lshlrev_b32 v7, 4, v1
    v_add_u32 v48, s40, v7
    s_mov_b32 s35, 0x05040100
    s_mov_b32 s36, 0x07060302
    s_lshl_b32 s40, s39, 2
    s_mul_i32 s40, s40, 14
    s_lshl_b32 s41, s38, 1
    s_add_u32 s40, s40, s41
    s_lshl_b32 s40, s40, 10
    s_waitcnt vmcnt(0)
    v_cmp_eq_u32 vcc, 3, v6
    s_nop 1
    v_cndmask_b32_e64 v10, v10, 0, vcc
    v_cndmask_b32_e64 v11, v11, 0, vcc
    v_cndmask_b32_e64 v14, v14, 0, vcc
    v_cndmask_b32_e64 v15, v15, 0, vcc
    v_cndmask_b32_e64 v18, v18, 0, vcc
    v_cndmask_b32_e64 v19, v19, 0, vcc
    v_cndmask_b32_e64 v22, v22, 0, vcc
    v_cndmask_b32_e64 v23, v23, 0, vcc
    v_cndmask_b32_e64 v26, v26, 0, vcc
    v_cndmask_b32_e64 v27, v27, 0, vcc
    v_cndmask_b32_e64 v30, v30, 0, vcc
    v_cndmask_b32_e64 v31, v31, 0, vcc
    v_cndmask_b32_e64 v34, v34, 0, vcc
    v_cndmask_b32_e64 v35, v35, 0, vcc
    v_cndmask_b32_e64 v38, v38, 0, vcc
    v_cndmask_b32_e64 v39, v39, 0, vcc
    v_perm_b32 v40, v12, v8, s35
    v_perm_b32 v41, v20, v16, s35
    v_perm_b32 v42, v28, v24, s35
    v_perm_b32 v43, v36, v32, s35
    ds_write_b128 v5, v[40:43] offset:0
    v_perm_b32 v44, v12, v8, s36
    v_perm_b32 v45, v20, v16, s36
    v_perm_b32 v46, v28, v24, s36
    v_perm_b32 v47, v36, v32, s36
    ds_write_b128 v5, v[44:47] offset:16
    v_perm_b32 v40, v13, v9, s35
    v_perm_b32 v41, v21, v17, s35
    v_perm_b32 v42, v29, v25, s35
    v_perm_b32 v43, v37, v33, s35
    ds_write_b128 v5, v[40:43] offset:32
    v_perm_b32 v44, v13, v9, s36
    v_perm_b32 v45, v21, v17, s36
    v_perm_b32 v46, v29, v25, s36
    v_perm_b32 v47, v37, v33, s36
    ds_write_b128 v5, v[44:47] offset:48
    v_perm_b32 v40, v14, v10, s35
    v_perm_b32 v41, v22, v18, s35
    v_perm_b32 v42, v30, v26, s35
    v_perm_b32 v43, v38, v34, s35
    ds_write_b128 v5, v[40:43] offset:64
    v_perm_b32 v44, v14, v10, s36
    v_perm_b32 v45, v22, v18, s36
    v_perm_b32 v46, v30, v26, s36
    v_perm_b32 v47, v38, v34, s36
    ds_write_b128 v5, v[44:47] offset:80
    v_perm_b32 v40, v15, v11, s35
    v_perm_b32 v41, v23, v19, s35
    v_perm_b32 v42, v31, v27, s35
    v_perm_b32 v43, v39, v35, s35
    ds_write_b128 v5, v[40:43] offset:96
    v_perm_b32 v44, v15, v11, s36
    v_perm_b32 v45, v23, v19, s36
    v_perm_b32 v46, v31, v27, s36
    v_perm_b32 v47, v39, v35, s36
    ds_write_b128 v5, v[44:47] offset:112
    s_waitcnt lgkmcnt(0)
    ds_read_b128 v[8:11], v48 offset:0
    ds_read_b128 v[12:15], v48 offset:1024
    ds_read_b128 v[16:19], v48 offset:2048
    ds_read_b128 v[20:23], v48 offset:3072
    ds_read_b128 v[24:27], v48 offset:4096
    ds_read_b128 v[28:31], v48 offset:5120
    ds_read_b128 v[32:35], v48 offset:6144
    ds_read_b128 v[36:39], v48 offset:7168
    s_add_u32 s41, s40, 0
    s_waitcnt lgkmcnt(7)
    buffer_store_dwordx4 v[8:11], v7, s[28:31], s41 offen sc1
    s_add_u32 s41, s40, 14336
    s_waitcnt lgkmcnt(6)
    buffer_store_dwordx4 v[12:15], v7, s[28:31], s41 offen sc1
    s_add_u32 s41, s40, 28672
    s_waitcnt lgkmcnt(5)
    buffer_store_dwordx4 v[16:19], v7, s[28:31], s41 offen sc1
    s_add_u32 s41, s40, 43008
    s_waitcnt lgkmcnt(4)
    buffer_store_dwordx4 v[20:23], v7, s[28:31], s41 offen sc1
    s_add_u32 s41, s40, 1024
    s_waitcnt lgkmcnt(3)
    buffer_store_dwordx4 v[24:27], v7, s[28:31], s41 offen sc1
    s_add_u32 s41, s40, 15360
    s_waitcnt lgkmcnt(2)
    buffer_store_dwordx4 v[28:31], v7, s[28:31], s41 offen sc1
    s_add_u32 s41, s40, 29696
    s_waitcnt lgkmcnt(1)
    buffer_store_dwordx4 v[32:35], v7, s[28:31], s41 offen sc1
    s_add_u32 s41, s40, 44032
    s_waitcnt lgkmcnt(0)
    buffer_store_dwordx4 v[36:39], v7, s[28:31], s41 offen sc1
L_prep_end_1:
    s_endpgm
L_k1_ln:
    s_mov_b32 s24, s4
    s_and_b32 s25, s5, 0xffff
    s_mov_b32 s26, 1835008
    s_mov_b32 s27, 0x00020000
    s_add_u32 s28, s20, 16384
    s_addc_u32 s29, s21, 0
    s_and_b32 s29, s29, 0xffff
    s_mov_b32 s30, 1835008
    s_mov_b32 s31, 0x00020000
    s_sub_u32 s3, s2, 84
    s_lshl_b32 s3, s3, 5
    v_lshrrev_b32 v1, 3, v0
    v_add_u32 v1, s3, v1
    v_mul_u32_u24 v1, 896, v1
    v_and_b32 v2, 7, v0
    v_lshl_add_u32 v1, v2, 4, v1
    buffer_load_dwordx4 v[8:11], v1, s[24:27], 0 offen offset:0
    buffer_load_dwordx4 v[12:15], v1, s[24:27], 0 offen offset:128
    buffer_load_dwordx4 v[16:19], v1, s[24:27], 0 offen offset:256
    buffer_load_dwordx4 v[20:23], v1, s[24:27], 0 offen offset:384
    buffer_load_dwordx4 v[24:27], v1, s[24:27], 0 offen offset:512
    buffer_load_dwordx4 v[28:31], v1, s[24:27], 0 offen offset:640
    buffer_load_dwordx4 v[32:35], v1, s[24:27], 0 offen offset:768
    s_waitcnt vmcnt(0)
    v_lshlrev_b32 v40, 16, v8
    v_and_b32 v41, 0xffff0000, v8
    v_lshlrev_b32 v42, 16, v9
    v_and_b32 v43, 0xffff0000, v9
    v_lshlrev_b32 v44, 16, v10
    v_and_b32 v45, 0xffff0000, v10
    v_lshlrev_b32 v46, 16, v11
    v_and_b32 v47, 0xffff0000, v11
    v_lshlrev_b32 v48, 16, v12
    v_and_b32 v49, 0xffff0000, v12
    v_lshlrev_b32 v50, 16, v13
    v_and_b32 v51, 0xffff0000, v13
    v_lshlrev_b32 v52, 16, v14
    v_and_b32 v53, 0xffff0000, v14
    v_lshlrev_b32 v54, 16, v15
    v_and_b32 v55, 0xffff0000, v15
    v_lshlrev_b32 v56, 16, v16
    v_and_b32 v57, 0xffff0000, v16
    v_lshlrev_b32 v58, 16, v17
    v_and_b32 v59, 0xffff0000, v17
    v_lshlrev_b32 v60, 16, v18
    v_and_b32 v61, 0xffff0000, v18
    v_lshlrev_b32 v62, 16, v19
    v_and_b32 v63, 0xffff0000, v19
    v_lshlrev_b32 v64, 16, v20
    v_and_b32 v65, 0xffff0000, v20
    v_lshlrev_b32 v66, 16, v21
    v_and_b32 v67, 0xffff0000, v21
    v_lshlrev_b32 v68, 16, v22
    v_and_b32 v69, 0xffff0000, v22
    v_lshlrev_b32 v70, 16, v23
    v_and_b32 v71, 0xffff0000, v23
    v_lshlrev_b32 v72, 16, v24
    v_and_b32 v73, 0xffff0000, v24
    v_lshlrev_b32 v74, 16, v25
    v_and_b32 v75, 0xffff0000, v25
    v_lshlrev_b32 v76, 16, v26
    v_and_b32 v77, 0xffff0000, v26
    v_lshlrev_b32 v78, 16, v27
    v_and_b32 v79, 0xffff0000, v27
    v_lshlrev_b32 v80, 16, v28
    v_and_b32 v81, 0xffff0000, v28
    v_lshlrev_b32 v82, 16, v29
    v_and_b32 v83, 0xffff0000, v29
    v_lshlrev_b32 v84, 16, v30
    v_and_b32 v85, 0xffff0000, v30
    v_lshlrev_b32 v86, 16, v31
    v_and_b32 v87, 0xffff0000, v31
    v_lshlrev_b32 v88, 16, v32
    v_and_b32 v89, 0xffff0000, v32
    v_lshlrev_b32 v90, 16, v33
    v_and_b32 v91, 0xffff0000, v33
    v_lshlrev_b32 v92, 16, v34
    v_and_b32 v93, 0xffff0000, v34
    v_lshlrev_b32 v94, 16, v35
    v_and_b32 v95, 0xffff0000, v35
    v_add_f32 v2, v40, v41
    v_add_f32 v3, v42, v43
    v_add_f32 v4, v44, v45
    v_add_f32 v5, v46, v47
    v_add_f32 v2, v2, v48
    v_add_f32 v3, v3, v49
    v_add_f32 v4, v4, v50
    v_add_f32 v5, v5, v51
    v_add_f32 v2, v2, v52
    v_add_f32 v3, v3, v53
    v_add_f32 v4, v4, v54
    v_add_f32 v5, v5, v55
    v_add_f32 v2, v2, v56
    v_add_f32 v3, v3, v57
    v_add_f32 v4, v4, v58
    v_add_f32 v5, v5, v59
    v_add_f32 v2, v2, v60
    v_add_f32 v3, v3, v61
    v_add_f32 v4, v4, v62
    v_add_f32 v5, v5, v63
    v_add_f32 v2, v2, v64
    v_add_f32 v3, v3, v65
    v_add_f32 v4, v4, v66
    v_add_f32 v5, v5, v67
    v_add_f32 v2, v2, v68
    v_add_f32 v3, v3, v69
    v_add_f32 v4, v4, v70
    v_add_f32 v5, v5, v71
    v_add_f32 v2, v2, v72
    v_add_f32 v3, v3, v73
    v_add_f32 v4, v4, v74
    v_add_f32 v5, v5, v75
    v_add_f32 v2, v2, v76
    v_add_f32 v3, v3, v77
    v_add_f32 v4, v4, v78
    v_add_f32 v5, v5, v79
    v_add_f32 v2, v2, v80
    v_add_f32 v3, v3, v81
    v_add_f32 v4, v4, v82
    v_add_f32 v5, v5, v83
    v_add_f32 v2, v2, v84
    v_add_f32 v3, v3, v85
    v_add_f32 v4, v4, v86
    v_add_f32 v5, v5, v87
    v_add_f32 v2, v2, v88
    v_add_f32 v3, v3, v89
    v_add_f32 v4, v4, v90
    v_add_f32 v5, v5, v91
    v_add_f32 v2, v2, v92
    v_add_f32 v3, v3, v93
    v_add_f32 v4, v4, v94
    v_add_f32 v5, v5, v95
    v_add_f32 v2, v2, v3
    v_add_f32 v4, v4, v5
    v_add_f32 v2, v2, v4
    s_nop 1
    v_add_f32_dpp v2, v2, v2 quad_perm:[1,0,3,2] row_mask:0xf bank_mask:0xf
    s_nop 1
    v_add_f32_dpp v2, v2, v2 quad_perm:[2,3,0,1] row_mask:0xf bank_mask:0xf
    s_nop 1
    v_add_f32_dpp v2, v2, v2 row_half_mirror row_mask:0xf bank_mask:0xf
    v_mul_f32 v2, 0.002232142857142857, v2
    v_sub_f32 v40, v40, v2
    v_sub_f32 v41, v41, v2
    v_sub_f32 v42, v42, v2
    v_sub_f32 v43, v43, v2
    v_sub_f32 v44, v44, v2
    v_sub_f32 v45, v45, v2
    v_sub_f32 v46, v46, v2
    v_sub_f32 v47, v47, v2
    v_sub_f32 v48, v48, v2
    v_sub_f32 v49, v49, v2
    v_sub_f32 v50, v50, v2
    v_sub_f32 v51, v51, v2
    v_sub_f32 v52, v52, v2
    v_sub_f32 v53, v53, v2
    v_sub_f32 v54, v54, v2
    v_sub_f32 v55, v55, v2
    v_sub_f32 v56, v56, v2
    v_sub_f32 v57, v57, v2
    v_sub_f32 v58, v58, v2
    v_sub_f32 v59, v59, v2
    v_sub_f32 v60, v60, v2
    v_sub_f32 v61, v61, v2
    v_sub_f32 v62, v62, v2
    v_sub_f32 v63, v63, v2
    v_sub_f32 v64, v64, v2
    v_sub_f32 v65, v65, v2
    v_sub_f32 v66, v66, v2
    v_sub_f32 v67, v67, v2
    v_sub_f32 v68, v68, v2
    v_sub_f32 v69, v69, v2
    v_sub_f32 v70, v70, v2
    v_sub_f32 v71, v71, v2
    v_sub_f32 v72, v72, v2
    v_sub_f32 v73, v73, v2
    v_sub_f32 v74, v74, v2
    v_sub_f32 v75, v75, v2
    v_sub_f32 v76, v76, v2
    v_sub_f32 v77, v77, v2
    v_sub_f32 v78, v78, v2
    v_sub_f32 v79, v79, v2
    v_sub_f32 v80, v80, v2
    v_sub_f32 v81, v81, v2
    v_sub_f32 v82, v82, v2
    v_sub_f32 v83, v83, v2
    v_sub_f32 v84, v84, v2
    v_sub_f32 v85, v85, v2
    v_sub_f32 v86, v86, v2
    v_sub_f32 v87, v87, v2
    v_sub_f32 v88, v88, v2
    v_sub_f32 v89, v89, v2
    v_sub_f32 v90, v90, v2
    v_sub_f32 v91, v91, v2
    v_sub_f32 v92, v92, v2
    v_sub_f32 v93, v93, v2
    v_sub_f32 v94, v94, v2
    v_sub_f32 v95, v95, v2
    v_mul_f32 v3, v40, v40
    v_mul_f32 v4, v41, v41
    v_mul_f32 v5, v42, v42
    v_mul_f32 v6, v43, v43
    v_fmac_f32 v3, v44, v44
    v_fmac_f32 v4, v45, v45
    v_fmac_f32 v5, v46, v46
    v_fmac_f32 v6, v47, v47
    v_fmac_f32 v3, v48, v48
    v_fmac_f32 v4, v49, v49
    v_fmac_f32 v5, v50, v50
    v_fmac_f32 v6, v51, v51
    v_fmac_f32 v3, v52, v52
    v_fmac_f32 v4, v53, v53
    v_fmac_f32 v5, v54, v54
    v_fmac_f32 v6, v55, v55
    v_fmac_f32 v3, v56, v56
    v_fmac_f32 v4, v57, v57
    v_fmac_f32 v5, v58, v58
    v_fmac_f32 v6, v59, v59
    v_fmac_f32 v3, v60, v60
    v_fmac_f32 v4, v61, v61
    v_fmac_f32 v5, v62, v62
    v_fmac_f32 v6, v63, v63
    v_fmac_f32 v3, v64, v64
    v_fmac_f32 v4, v65, v65
    v_fmac_f32 v5, v66, v66
    v_fmac_f32 v6, v67, v67
    v_fmac_f32 v3, v68, v68
    v_fmac_f32 v4, v69, v69
    v_fmac_f32 v5, v70, v70
    v_fmac_f32 v6, v71, v71
    v_fmac_f32 v3, v72, v72
    v_fmac_f32 v4, v73, v73
    v_fmac_f32 v5, v74, v74
    v_fmac_f32 v6, v75, v75
    v_fmac_f32 v3, v76, v76
    v_fmac_f32 v4, v77, v77
    v_fmac_f32 v5, v78, v78
    v_fmac_f32 v6, v79, v79
    v_fmac_f32 v3, v80, v80
    v_fmac_f32 v4, v81, v81
    v_fmac_f32 v5, v82, v82
    v_fmac_f32 v6, v83, v83
    v_fmac_f32 v3, v84, v84
    v_fmac_f32 v4, v85, v85
    v_fmac_f32 v5, v86, v86
    v_fmac_f32 v6, v87, v87
    v_fmac_f32 v3, v88, v88
    v_fmac_f32 v4, v89, v89
    v_fmac_f32 v5, v90, v90
    v_fmac_f32 v6, v91, v91
    v_fmac_f32 v3, v92, v92
    v_fmac_f32 v4, v93, v93
    v_fmac_f32 v5, v94, v94
    v_fmac_f32 v6, v95, v95
    v_add_f32 v3, v3, v4
    v_add_f32 v5, v5, v6
    v_add_f32 v3, v3, v5
    s_nop 1
    v_add_f32_dpp v3, v3, v3 quad_perm:[1,0,3,2] row_mask:0xf bank_mask:0xf
    s_nop 1
    v_add_f32_dpp v3, v3, v3 quad_perm:[2,3,0,1] row_mask:0xf bank_mask:0xf
    s_nop 1
    v_add_f32_dpp v3, v3, v3 row_half_mirror row_mask:0xf bank_mask:0xf
    v_mov_b32 v4, 0x3727c5ac
    v_fmac_f32 v4, 0.002232142857142857, v3
    v_rsq_f32 v4, v4
    s_nop 0
    v_mul_f32 v40, v40, v4
    v_mul_f32 v41, v41, v4
    v_mul_f32 v42, v42, v4
    v_mul_f32 v43, v43, v4
    v_mul_f32 v44, v44, v4
    v_mul_f32 v45, v45, v4
    v_mul_f32 v46, v46, v4
    v_mul_f32 v47, v47, v4
    v_mul_f32 v48, v48, v4
    v_mul_f32 v49, v49, v4
    v_mul_f32 v50, v50, v4
    v_mul_f32 v51, v51, v4
    v_mul_f32 v52, v52, v4
    v_mul_f32 v53, v53, v4
    v_mul_f32 v54, v54, v4
    v_mul_f32 v55, v55, v4
    v_mul_f32 v56, v56, v4
    v_mul_f32 v57, v57, v4
    v_mul_f32 v58, v58, v4
    v_mul_f32 v59, v59, v4
    v_mul_f32 v60, v60, v4
    v_mul_f32 v61, v61, v4
    v_mul_f32 v62, v62, v4
    v_mul_f32 v63, v63, v4
    v_mul_f32 v64, v64, v4
    v_mul_f32 v65, v65, v4
    v_mul_f32 v66, v66, v4
    v_mul_f32 v67, v67, v4
    v_mul_f32 v68, v68, v4
    v_mul_f32 v69, v69, v4
    v_mul_f32 v70, v70, v4
    v_mul_f32 v71, v71, v4
    v_mul_f32 v72, v72, v4
    v_mul_f32 v73, v73, v4
    v_mul_f32 v74, v74, v4
    v_mul_f32 v75, v75, v4
    v_mul_f32 v76, v76, v4
    v_mul_f32 v77, v77, v4
    v_mul_f32 v78, v78, v4
    v_mul_f32 v79, v79, v4
    v_mul_f32 v80, v80, v4
    v_mul_f32 v81, v81, v4
    v_mul_f32 v82, v82, v4
    v_mul_f32 v83, v83, v4
    v_mul_f32 v84, v84, v4
    v_mul_f32 v85, v85, v4
    v_mul_f32 v86, v86, v4
    v_mul_f32 v87, v87, v4
    v_mul_f32 v88, v88, v4
    v_mul_f32 v89, v89, v4
    v_mul_f32 v90, v90, v4
    v_mul_f32 v91, v91, v4
    v_mul_f32 v92, v92, v4
    v_mul_f32 v93, v93, v4
    v_mul_f32 v94, v94, v4
    v_mul_f32 v95, v95, v4
    v_cvt_pk_bf16_f32 v8, v40, v41
    v_cvt_pk_bf16_f32 v9, v42, v43
    v_cvt_pk_bf16_f32 v10, v44, v45
    v_cvt_pk_bf16_f32 v11, v46, v47
    v_cvt_pk_bf16_f32 v12, v48, v49
    v_cvt_pk_bf16_f32 v13, v50, v51
    v_cvt_pk_bf16_f32 v14, v52, v53
    v_cvt_pk_bf16_f32 v15, v54, v55
    v_cvt_pk_bf16_f32 v16, v56, v57
    v_cvt_pk_bf16_f32 v17, v58, v59
    v_cvt_pk_bf16_f32 v18, v60, v61
    v_cvt_pk_bf16_f32 v19, v62, v63
    v_cvt_pk_bf16_f32 v20, v64, v65
    v_cvt_pk_bf16_f32 v21, v66, v67
    v_cvt_pk_bf16_f32 v22, v68, v69
    v_cvt_pk_bf16_f32 v23, v70, v71
    v_cvt_pk_bf16_f32 v24, v72, v73
    v_cvt_pk_bf16_f32 v25, v74, v75
    v_cvt_pk_bf16_f32 v26, v76, v77
    v_cvt_pk_bf16_f32 v27, v78, v79
    v_cvt_pk_bf16_f32 v28, v80, v81
    v_cvt_pk_bf16_f32 v29, v82, v83
    v_cvt_pk_bf16_f32 v30, v84, v85
    v_cvt_pk_bf16_f32 v31, v86, v87
    v_cvt_pk_bf16_f32 v32, v88, v89
    v_cvt_pk_bf16_f32 v33, v90, v91
    v_cvt_pk_bf16_f32 v34, v92, v93
    v_cvt_pk_bf16_f32 v35, v94, v95
    buffer_store_dwordx4 v[8:11], v1, s[28:31], 0 offen offset:0 sc1
    buffer_store_dwordx4 v[12:15], v1, s[28:31], 0 offen offset:128 sc1
    buffer_store_dwordx4 v[16:19], v1, s[28:31], 0 offen offset:256 sc1
    buffer_store_dwordx4 v[20:23], v1, s[28:31], 0 offen offset:384 sc1
    buffer_store_dwordx4 v[24:27], v1, s[28:31], 0 offen offset:512 sc1
    buffer_store_dwordx4 v[28:31], v1, s[28:31], 0 offen offset:640 sc1
    buffer_store_dwordx4 v[32:35], v1, s[28:31], 0 offen offset:768 sc1
    s_endpgm
L_k1_mod:
    s_mov_b32 s24, s18
    s_and_b32 s25, s19, 0xffff
    s_mov_b32 s26, 2408448
    s_mov_b32 s27, 0x00020000
    s_mov_b32 s28, s16
    s_and_b32 s29, s17, 0xffff
    s_mov_b32 s30, 896
    s_mov_b32 s31, 0x00020000
    s_mov_b32 s32, s20
    s_and_b32 s33, s21, 0xffff
    s_mov_b32 s34, 10752
    s_mov_b32 s35, 0x00020000
    v_and_b32 v1, 3, v0
    v_lshrrev_b32 v2, 2, v0
    v_mul_u32_u24 v3, 5376, v2
    v_lshl_add_u32 v3, v1, 4, v3
    s_lshl_b32 s3, s2, 6
    v_add_u32 v3, s3, v3
    v_lshlrev_b32 v4, 1, v2
    buffer_load_ushort v36, v4, s[28:31], 0 offen offset:0
    buffer_load_ushort v37, v4, s[28:31], 0 offen offset:128
    buffer_load_ushort v38, v4, s[28:31], 0 offen offset:256
    buffer_load_ushort v39, v4, s[28:31], 0 offen offset:384
    buffer_load_ushort v40, v4, s[28:31], 0 offen offset:512
    buffer_load_ushort v41, v4, s[28:31], 0 offen offset:640
    buffer_load_ushort v42, v4, s[28:31], 0 offen offset:768
    s_mov_b32 s36, 0
    buffer_load_dwordx4 v[8:11], v3, s[24:27], s36 offen
    s_mov_b32 s36, 344064
    buffer_load_dwordx4 v[12:15], v3, s[24:27], s36 offen
    s_mov_b32 s36, 688128
    buffer_load_dwordx4 v[16:19], v3, s[24:27], s36 offen
    s_mov_b32 s36, 1032192
    buffer_load_dwordx4 v[20:23], v3, s[24:27], s36 offen
    s_mov_b32 s36, 1376256
    buffer_load_dwordx4 v[24:27], v3, s[24:27], s36 offen
    s_mov_b32 s36, 1720320
    buffer_load_dwordx4 v[28:31], v3, s[24:27], s36 offen
    s_mov_b32 s36, 2064384
    buffer_load_dwordx4 v[32:35], v3, s[24:27], s36 offen
    s_waitcnt vmcnt(7)
    v_lshlrev_b32 v36, 16, v36
    v_mul_f32 v44, 0xbfb8aa3b, v36
    v_lshlrev_b32 v37, 16, v37
    v_mul_f32 v45, 0xbfb8aa3b, v37
    v_lshlrev_b32 v38, 16, v38
    v_mul_f32 v46, 0xbfb8aa3b, v38
    v_lshlrev_b32 v39, 16, v39
    v_mul_f32 v47, 0xbfb8aa3b, v39
    v_lshlrev_b32 v40, 16, v40
    v_mul_f32 v48, 0xbfb8aa3b, v40
    v_lshlrev_b32 v41, 16, v41
    v_mul_f32 v49, 0xbfb8aa3b, v41
    v_lshlrev_b32 v42, 16, v42
    v_mul_f32 v50, 0xbfb8aa3b, v42
    v_exp_f32 v44, v44
    v_exp_f32 v45, v45
    v_exp_f32 v46, v46
    v_exp_f32 v47, v47
    v_exp_f32 v48, v48
    v_exp_f32 v49, v49
    v_exp_f32 v50, v50
    s_nop 0
    v_add_f32 v44, 1.0, v44
    v_add_f32 v45, 1.0, v45
    v_add_f32 v46, 1.0, v46
    v_add_f32 v47, 1.0, v47
    v_add_f32 v48, 1.0, v48
    v_add_f32 v49, 1.0, v49
    v_add_f32 v50, 1.0, v50
    v_rcp_f32 v44, v44
    v_rcp_f32 v45, v45
    v_rcp_f32 v46, v46
    v_rcp_f32 v47, v47
    v_rcp_f32 v48, v48
    v_rcp_f32 v49, v49
    v_rcp_f32 v50, v50
    s_nop 0
    v_mul_f32 v36, v36, v44
    v_mul_f32 v37, v37, v45
    v_mul_f32 v38, v38, v46
    v_mul_f32 v39, v39, v47
    v_mul_f32 v40, v40, v48
    v_mul_f32 v41, v41, v49
    v_mul_f32 v42, v42, v50
    v_cvt_pk_bf16_f32 v36, v36, v36
    v_cvt_pk_bf16_f32 v37, v37, v37
    v_cvt_pk_bf16_f32 v38, v38, v38
    v_cvt_pk_bf16_f32 v39, v39, v39
    v_cvt_pk_bf16_f32 v40, v40, v40
    v_cvt_pk_bf16_f32 v41, v41, v41
    v_cvt_pk_bf16_f32 v42, v42, v42
    v_lshlrev_b32 v36, 16, v36
    v_lshlrev_b32 v37, 16, v37
    v_lshlrev_b32 v38, 16, v38
    v_lshlrev_b32 v39, 16, v39
    v_lshlrev_b32 v40, 16, v40
    v_lshlrev_b32 v41, 16, v41
    v_lshlrev_b32 v42, 16, v42
    s_waitcnt vmcnt(0)
    v_lshlrev_b32 v5, 16, v8
    v_and_b32 v6, 0xffff0000, v8
    v_mul_f32 v52, v36, v5
    v_mul_f32 v53, v36, v6
    v_lshlrev_b32 v5, 16, v9
    v_and_b32 v6, 0xffff0000, v9
    v_mul_f32 v54, v36, v5
    v_mul_f32 v55, v36, v6
    v_lshlrev_b32 v5, 16, v10
    v_and_b32 v6, 0xffff0000, v10
    v_mul_f32 v56, v36, v5
    v_mul_f32 v57, v36, v6
    v_lshlrev_b32 v5, 16, v11
    v_and_b32 v6, 0xffff0000, v11
    v_mul_f32 v58, v36, v5
    v_mul_f32 v59, v36, v6
    v_lshlrev_b32 v5, 16, v12
    v_and_b32 v6, 0xffff0000, v12
    v_fmac_f32 v52, v37, v5
    v_fmac_f32 v53, v37, v6
    v_lshlrev_b32 v5, 16, v13
    v_and_b32 v6, 0xffff0000, v13
    v_fmac_f32 v54, v37, v5
    v_fmac_f32 v55, v37, v6
    v_lshlrev_b32 v5, 16, v14
    v_and_b32 v6, 0xffff0000, v14
    v_fmac_f32 v56, v37, v5
    v_fmac_f32 v57, v37, v6
    v_lshlrev_b32 v5, 16, v15
    v_and_b32 v6, 0xffff0000, v15
    v_fmac_f32 v58, v37, v5
    v_fmac_f32 v59, v37, v6
    v_lshlrev_b32 v5, 16, v16
    v_and_b32 v6, 0xffff0000, v16
    v_fmac_f32 v52, v38, v5
    v_fmac_f32 v53, v38, v6
    v_lshlrev_b32 v5, 16, v17
    v_and_b32 v6, 0xffff0000, v17
    v_fmac_f32 v54, v38, v5
    v_fmac_f32 v55, v38, v6
    v_lshlrev_b32 v5, 16, v18
    v_and_b32 v6, 0xffff0000, v18
    v_fmac_f32 v56, v38, v5
    v_fmac_f32 v57, v38, v6
    v_lshlrev_b32 v5, 16, v19
    v_and_b32 v6, 0xffff0000, v19
    v_fmac_f32 v58, v38, v5
    v_fmac_f32 v59, v38, v6
    v_lshlrev_b32 v5, 16, v20
    v_and_b32 v6, 0xffff0000, v20
    v_fmac_f32 v52, v39, v5
    v_fmac_f32 v53, v39, v6
    v_lshlrev_b32 v5, 16, v21
    v_and_b32 v6, 0xffff0000, v21
    v_fmac_f32 v54, v39, v5
    v_fmac_f32 v55, v39, v6
    v_lshlrev_b32 v5, 16, v22
    v_and_b32 v6, 0xffff0000, v22
    v_fmac_f32 v56, v39, v5
    v_fmac_f32 v57, v39, v6
    v_lshlrev_b32 v5, 16, v23
    v_and_b32 v6, 0xffff0000, v23
    v_fmac_f32 v58, v39, v5
    v_fmac_f32 v59, v39, v6
    v_lshlrev_b32 v5, 16, v24
    v_and_b32 v6, 0xffff0000, v24
    v_fmac_f32 v52, v40, v5
    v_fmac_f32 v53, v40, v6
    v_lshlrev_b32 v5, 16, v25
    v_and_b32 v6, 0xffff0000, v25
    v_fmac_f32 v54, v40, v5
    v_fmac_f32 v55, v40, v6
    v_lshlrev_b32 v5, 16, v26
    v_and_b32 v6, 0xffff0000, v26
    v_fmac_f32 v56, v40, v5
    v_fmac_f32 v57, v40, v6
    v_lshlrev_b32 v5, 16, v27
    v_and_b32 v6, 0xffff0000, v27
    v_fmac_f32 v58, v40, v5
    v_fmac_f32 v59, v40, v6
    v_lshlrev_b32 v5, 16, v28
    v_and_b32 v6, 0xffff0000, v28
    v_fmac_f32 v52, v41, v5
    v_fmac_f32 v53, v41, v6
    v_lshlrev_b32 v5, 16, v29
    v_and_b32 v6, 0xffff0000, v29
    v_fmac_f32 v54, v41, v5
    v_fmac_f32 v55, v41, v6
    v_lshlrev_b32 v5, 16, v30
    v_and_b32 v6, 0xffff0000, v30
    v_fmac_f32 v56, v41, v5
    v_fmac_f32 v57, v41, v6
    v_lshlrev_b32 v5, 16, v31
    v_and_b32 v6, 0xffff0000, v31
    v_fmac_f32 v58, v41, v5
    v_fmac_f32 v59, v41, v6
    v_lshlrev_b32 v5, 16, v32
    v_and_b32 v6, 0xffff0000, v32
    v_fmac_f32 v52, v42, v5
    v_fmac_f32 v53, v42, v6
    v_lshlrev_b32 v5, 16, v33
    v_and_b32 v6, 0xffff0000, v33
    v_fmac_f32 v54, v42, v5
    v_fmac_f32 v55, v42, v6
    v_lshlrev_b32 v5, 16, v34
    v_and_b32 v6, 0xffff0000, v34
    v_fmac_f32 v56, v42, v5
    v_fmac_f32 v57, v42, v6
    v_lshlrev_b32 v5, 16, v35
    v_and_b32 v6, 0xffff0000, v35
    v_fmac_f32 v58, v42, v5
    v_fmac_f32 v59, v42, v6
    v_lshlrev_b32 v5, 7, v2
    v_lshl_add_u32 v5, v1, 5, v5
    ds_write_b128 v5, v[52:55]
    ds_write_b128 v5, v[56:59] offset:16
    s_waitcnt lgkmcnt(0)
    s_barrier
    v_cmp_gt_u32 vcc, 64, v0
    s_and_saveexec_b64 s[36:37], vcc
    s_cbranch_execz L_k1_exit
    v_and_b32 v1, 31, v0
    v_lshrrev_b32 v2, 5, v0
    v_lshlrev_b32 v3, 2, v1
    v_lshl_add_u32 v3, v2, 12, v3
    ds_read_b32 v8, v3 offset:0
    ds_read_b32 v9, v3 offset:128
    ds_read_b32 v10, v3 offset:256
    ds_read_b32 v11, v3 offset:384
    ds_read_b32 v12, v3 offset:512
    ds_read_b32 v13, v3 offset:640
    ds_read_b32 v14, v3 offset:768
    ds_read_b32 v15, v3 offset:896
    ds_read_b32 v16, v3 offset:1024
    ds_read_b32 v17, v3 offset:1152
    ds_read_b32 v18, v3 offset:1280
    ds_read_b32 v19, v3 offset:1408
    ds_read_b32 v20, v3 offset:1536
    ds_read_b32 v21, v3 offset:1664
    ds_read_b32 v22, v3 offset:1792
    ds_read_b32 v23, v3 offset:1920
    ds_read_b32 v24, v3 offset:2048
    ds_read_b32 v25, v3 offset:2176
    ds_read_b32 v26, v3 offset:2304
    ds_read_b32 v27, v3 offset:2432
    ds_read_b32 v28, v3 offset:2560
    ds_read_b32 v29, v3 offset:2688
    ds_read_b32 v30, v3 offset:2816
    ds_read_b32 v31, v3 offset:2944
    ds_read_b32 v32, v3 offset:3072
    ds_read_b32 v33, v3 offset:3200
    ds_read_b32 v34, v3 offset:3328
    ds_read_b32 v35, v3 offset:3456
    ds_read_b32 v36, v3 offset:3584
    ds_read_b32 v37, v3 offset:3712
    ds_read_b32 v38, v3 offset:3840
    ds_read_b32 v39, v3 offset:3968
    s_waitcnt lgkmcnt(0)
    v_add_f32 v8, v8, v24
    v_add_f32 v9, v9, v25
    v_add_f32 v10, v10, v26
    v_add_f32 v11, v11, v27
    v_add_f32 v12, v12, v28
    v_add_f32 v13, v13, v29
    v_add_f32 v14, v14, v30
    v_add_f32 v15, v15, v31
    v_add_f32 v16, v16, v32
    v_add_f32 v17, v17, v33
    v_add_f32 v18, v18, v34
    v_add_f32 v19, v19, v35
    v_add_f32 v20, v20, v36
    v_add_f32 v21, v21, v37
    v_add_f32 v22, v22, v38
    v_add_f32 v23, v23, v39
    v_add_f32 v8, v8, v16
    v_add_f32 v9, v9, v17
    v_add_f32 v10, v10, v18
    v_add_f32 v11, v11, v19
    v_add_f32 v12, v12, v20
    v_add_f32 v13, v13, v21
    v_add_f32 v14, v14, v22
    v_add_f32 v15, v15, v23
    v_add_f32 v8, v8, v12
    v_add_f32 v9, v9, v13
    v_add_f32 v10, v10, v14
    v_add_f32 v11, v11, v15
    v_add_f32 v8, v8, v10
    v_add_f32 v9, v9, v11
    v_add_f32 v8, v8, v9
    v_mov_b32 v9, v8
    s_nop 1
    v_permlane32_swap_b32 v8, v9
    v_add_f32 v8, v8, v9
    v_cvt_pk_bf16_f32 v8, v8, v8
    v_lshlrev_b32 v8, 16, v8
    v_lshlrev_b32 v3, 2, v1
    s_lshl_b32 s3, s2, 7
    v_add_u32 v3, s3, v3
    v_cmp_gt_u32 vcc, 32, v0
    s_and_saveexec_b64 s[36:37], vcc
    buffer_store_dword v8, v3, s[32:35], 0 offen
L_k1_exit:
    s_endpgm
    .globl k2_kernel
    .p2align 8
    .type k2_kernel,@function
k2_kernel:
    s_load_dwordx16 s[4:19], s[0:1], 0
    s_load_dwordx2 s[20:21], s[0:1], 80
    s_cmp_ge_u32 s2, 249
    s_cbranch_scc1 L_k2_exit
    s_cmp_lt_u32 s2, 192
    s_cbranch_scc1 L_k2_gemm
    s_waitcnt lgkmcnt(0)
    s_cmp_lt_u32 s2, 199
    s_cbranch_scc1 L_k2_wo
    s_cmp_lt_u32 s2, 224
    s_cbranch_scc1 L_k2_w1
    s_mov_b32 s24, s14
    s_and_b32 s25, s15, 0xffff
    s_mov_b32 s26, 1605632
    s_mov_b32 s27, 0x00020000
    s_add_u32 s28, s20, 6291456
    s_addc_u32 s29, s21, 0
    s_and_b32 s29, s29, 0xffff
    s_mov_b32 s30, 1605632
    s_mov_b32 s31, 0x00020000
    v_lshrrev_b32 v1, 6, v0
    s_nop 0
    v_readfirstlane_b32 s37, v1
    s_sub_u32 s3, s2, 224
    s_lshl_b32 s3, s3, 3
    s_add_u32 s3, s3, s37
    s_cmp_ge_u32 s3, 196
    s_cbranch_scc1 L_prep_end_2
    s_mul_i32 s38, s3, 293
    s_lshr_b32 s38, s38, 11
    s_mul_i32 s39, s38, 7
    s_sub_u32 s39, s3, s39
    v_and_b32 v1, 63, v0
    v_lshrrev_b32 v2, 3, v1
    v_and_b32 v3, 7, v1
    s_lshl_b32 s40, s38, 3
    v_add_u32 v4, s40, v2
    v_mul_u32_u24 v4, 7168, v4
    s_lshl_b32 s40, s39, 3
    v_add_u32 v7, s40, v3
    v_lshl_add_u32 v4, v7, 4, v4
    s_mov_b32 s34, 0
    buffer_load_dwordx4 v[8:11], v4, s[24:27], s34 offen
    s_mov_b32 s34, 896
    buffer_load_dwordx4 v[12:15], v4, s[24:27], s34 offen
    s_mov_b32 s34, 1792
    buffer_load_dwordx4 v[16:19], v4, s[24:27], s34 offen
    s_mov_b32 s34, 2688
    buffer_load_dwordx4 v[20:23], v4, s[24:27], s34 offen
    s_mov_b32 s34, 3584
    buffer_load_dwordx4 v[24:27], v4, s[24:27], s34 offen
    s_mov_b32 s34, 4480
    buffer_load_dwordx4 v[28:31], v4, s[24:27], s34 offen
    s_mov_b32 s34, 5376
    buffer_load_dwordx4 v[32:35], v4, s[24:27], s34 offen
    s_mov_b32 s34, 6272
    buffer_load_dwordx4 v[36:39], v4, s[24:27], s34 offen
    v_lshrrev_b32 v5, 2, v2
    v_lshlrev_b32 v5, 12, v5
    v_lshrrev_b32 v7, 1, v3
    v_lshl_add_u32 v5, v7, 10, v5
    v_and_b32 v7, 3, v2
    v_lshl_add_u32 v5, v7, 8, v5
    v_and_b32 v7, 1, v3
    v_lshl_add_u32 v5, v7, 7, v5
    s_lshl_b32 s40, s37, 13
    v_add_u32 v5, s40, v5
    v_lshlrev_b32 v7, 4, v1
    v_add_u32 v48, s40, v7
    s_mov_b32 s35, 0x05040100
    s_mov_b32 s36, 0x07060302
    s_lshl_b32 s40, s39, 2
    s_mul_i32 s40, s40, 56
    s_lshl_b32 s41, s38, 1
    s_add_u32 s40, s40, s41
    s_lshl_b32 s40, s40, 10
    s_waitcnt vmcnt(0)
    v_perm_b32 v40, v12, v8, s35
    v_perm_b32 v41, v20, v16, s35
    v_perm_b32 v42, v28, v24, s35
    v_perm_b32 v43, v36, v32, s35
    ds_write_b128 v5, v[40:43] offset:0
    v_perm_b32 v44, v12, v8, s36
    v_perm_b32 v45, v20, v16, s36
    v_perm_b32 v46, v28, v24, s36
    v_perm_b32 v47, v36, v32, s36
    ds_write_b128 v5, v[44:47] offset:16
    v_perm_b32 v40, v13, v9, s35
    v_perm_b32 v41, v21, v17, s35
    v_perm_b32 v42, v29, v25, s35
    v_perm_b32 v43, v37, v33, s35
    ds_write_b128 v5, v[40:43] offset:32
    v_perm_b32 v44, v13, v9, s36
    v_perm_b32 v45, v21, v17, s36
    v_perm_b32 v46, v29, v25, s36
    v_perm_b32 v47, v37, v33, s36
    ds_write_b128 v5, v[44:47] offset:48
    v_perm_b32 v40, v14, v10, s35
    v_perm_b32 v41, v22, v18, s35
    v_perm_b32 v42, v30, v26, s35
    v_perm_b32 v43, v38, v34, s35
    ds_write_b128 v5, v[40:43] offset:64
    v_perm_b32 v44, v14, v10, s36
    v_perm_b32 v45, v22, v18, s36
    v_perm_b32 v46, v30, v26, s36
    v_perm_b32 v47, v38, v34, s36
    ds_write_b128 v5, v[44:47] offset:80
    v_perm_b32 v40, v15, v11, s35
    v_perm_b32 v41, v23, v19, s35
    v_perm_b32 v42, v31, v27, s35
    v_perm_b32 v43, v39, v35, s35
    ds_write_b128 v5, v[40:43] offset:96
    v_perm_b32 v44, v15, v11, s36
    v_perm_b32 v45, v23, v19, s36
    v_perm_b32 v46, v31, v27, s36
    v_perm_b32 v47, v39, v35, s36
    ds_write_b128 v5, v[44:47] offset:112
    s_waitcnt lgkmcnt(0)
    ds_read_b128 v[8:11], v48 offset:0
    ds_read_b128 v[12:15], v48 offset:1024
    ds_read_b128 v[16:19], v48 offset:2048
    ds_read_b128 v[20:23], v48 offset:3072
    ds_read_b128 v[24:27], v48 offset:4096
    ds_read_b128 v[28:31], v48 offset:5120
    ds_read_b128 v[32:35], v48 offset:6144
    ds_read_b128 v[36:39], v48 offset:7168
    s_add_u32 s41, s40, 0
    s_waitcnt lgkmcnt(7)
    buffer_store_dwordx4 v[8:11], v7, s[28:31], s41 offen sc1
    s_add_u32 s41, s40, 57344
    s_waitcnt lgkmcnt(6)
    buffer_store_dwordx4 v[12:15], v7, s[28:31], s41 offen sc1
    s_add_u32 s41, s40, 114688
    s_waitcnt lgkmcnt(5)
    buffer_store_dwordx4 v[16:19], v7, s[28:31], s41 offen sc1
    s_add_u32 s41, s40, 172032
    s_waitcnt lgkmcnt(4)
    buffer_store_dwordx4 v[20:23], v7, s[28:31], s41 offen sc1
    s_add_u32 s41, s40, 1024
    s_waitcnt lgkmcnt(3)
    buffer_store_dwordx4 v[24:27], v7, s[28:31], s41 offen sc1
    s_add_u32 s41, s40, 58368
    s_waitcnt lgkmcnt(2)
    buffer_store_dwordx4 v[28:31], v7, s[28:31], s41 offen sc1
    s_add_u32 s41, s40, 115712
    s_waitcnt lgkmcnt(1)
    buffer_store_dwordx4 v[32:35], v7, s[28:31], s41 offen sc1
    s_add_u32 s41, s40, 173056
    s_waitcnt lgkmcnt(0)
    buffer_store_dwordx4 v[36:39], v7, s[28:31], s41 offen sc1
L_prep_end_2:
    s_endpgm
L_k2_w1:
    s_mov_b32 s24, s12
    s_and_b32 s25, s13, 0xffff
    s_mov_b32 s26, 1605632
    s_mov_b32 s27, 0x00020000
    s_add_u32 s28, s20, 4194304
    s_addc_u32 s29, s21, 0
    s_and_b32 s29, s29, 0xffff
    s_mov_b32 s30, 1605632
    s_mov_b32 s31, 0x00020000
    v_lshrrev_b32 v1, 6, v0
    s_nop 0
    v_readfirstlane_b32 s37, v1
    s_sub_u32 s3, s2, 199
    s_lshl_b32 s3, s3, 3
    s_add_u32 s3, s3, s37
    s_cmp_ge_u32 s3, 196
    s_cbranch_scc1 L_prep_end_3
    s_mul_i32 s38, s3, 147
    s_lshr_b32 s38, s38, 12
    s_mul_i32 s39, s38, 28
    s_sub_u32 s39, s3, s39
    v_and_b32 v1, 63, v0
    v_lshrrev_b32 v2, 3, v1
    v_and_b32 v3, 7, v1
    s_lshl_b32 s40, s38, 3
    v_add_u32 v4, s40, v2
    v_mul_u32_u24 v4, 28672, v4
    s_lshl_b32 s40, s39, 3
    v_add_u32 v7, s40, v3
    v_lshl_add_u32 v4, v7, 4, v4
    s_mov_b32 s34, 0
    buffer_load_dwordx4 v[8:11], v4, s[24:27], s34 offen
    s_mov_b32 s34, 3584
    buffer_load_dwordx4 v[12:15], v4, s[24:27], s34 offen
    s_mov_b32 s34, 7168
    buffer_load_dwordx4 v[16:19], v4, s[24:27], s34 offen
    s_mov_b32 s34, 10752
    buffer_load_dwordx4 v[20:23], v4, s[24:27], s34 offen
    s_mov_b32 s34, 14336
    buffer_load_dwordx4 v[24:27], v4, s[24:27], s34 offen
    s_mov_b32 s34, 17920
    buffer_load_dwordx4 v[28:31], v4, s[24:27], s34 offen
    s_mov_b32 s34, 21504
    buffer_load_dwordx4 v[32:35], v4, s[24:27], s34 offen
    s_mov_b32 s34, 25088
    buffer_load_dwordx4 v[36:39], v4, s[24:27], s34 offen
    v_lshrrev_b32 v5, 2, v2
    v_lshlrev_b32 v5, 12, v5
    v_lshrrev_b32 v7, 1, v3
    v_lshl_add_u32 v5, v7, 10, v5
    v_and_b32 v7, 3, v2
    v_lshl_add_u32 v5, v7, 8, v5
    v_and_b32 v7, 1, v3
    v_lshl_add_u32 v5, v7, 7, v5
    s_lshl_b32 s40, s37, 13
    v_add_u32 v5, s40, v5
    v_lshlrev_b32 v7, 4, v1
    v_add_u32 v48, s40, v7
    s_mov_b32 s35, 0x05040100
    s_mov_b32 s36, 0x07060302
    s_lshl_b32 s40, s39, 2
    s_mul_i32 s40, s40, 14
    s_lshl_b32 s41, s38, 1
    s_add_u32 s40, s40, s41
    s_lshl_b32 s40, s40, 10
    s_waitcnt vmcnt(0)
    v_perm_b32 v40, v12, v8, s35
    v_perm_b32 v41, v20, v16, s35
    v_perm_b32 v42, v28, v24, s35
    v_perm_b32 v43, v36, v32, s35
    ds_write_b128 v5, v[40:43] offset:0
    v_perm_b32 v44, v12, v8, s36
    v_perm_b32 v45, v20, v16, s36
    v_perm_b32 v46, v28, v24, s36
    v_perm_b32 v47, v36, v32, s36
    ds_write_b128 v5, v[44:47] offset:16
    v_perm_b32 v40, v13, v9, s35
    v_perm_b32 v41, v21, v17, s35
    v_perm_b32 v42, v29, v25, s35
    v_perm_b32 v43, v37, v33, s35
    ds_write_b128 v5, v[40:43] offset:32
    v_perm_b32 v44, v13, v9, s36
    v_perm_b32 v45, v21, v17, s36
    v_perm_b32 v46, v29, v25, s36
    v_perm_b32 v47, v37, v33, s36
    ds_write_b128 v5, v[44:47] offset:48
    v_perm_b32 v40, v14, v10, s35
    v_perm_b32 v41, v22, v18, s35
    v_perm_b32 v42, v30, v26, s35
    v_perm_b32 v43, v38, v34, s35
    ds_write_b128 v5, v[40:43] offset:64
    v_perm_b32 v44, v14, v10, s36
    v_perm_b32 v45, v22, v18, s36
    v_perm_b32 v46, v30, v26, s36
    v_perm_b32 v47, v38, v34, s36
    ds_write_b128 v5, v[44:47] offset:80
    v_perm_b32 v40, v15, v11, s35
    v_perm_b32 v41, v23, v19, s35
    v_perm_b32 v42, v31, v27, s35
    v_perm_b32 v43, v39, v35, s35
    ds_write_b128 v5, v[40:43] offset:96
    v_perm_b32 v44, v15, v11, s36
    v_perm_b32 v45, v23, v19, s36
    v_perm_b32 v46, v31, v27, s36
    v_perm_b32 v47, v39, v35, s36
    ds_write_b128 v5, v[44:47] offset:112
    s_waitcnt lgkmcnt(0)
    ds_read_b128 v[8:11], v48 offset:0
    ds_read_b128 v[12:15], v48 offset:1024
    ds_read_b128 v[16:19], v48 offset:2048
    ds_read_b128 v[20:23], v48 offset:3072
    ds_read_b128 v[24:27], v48 offset:4096
    ds_read_b128 v[28:31], v48 offset:5120
    ds_read_b128 v[32:35], v48 offset:6144
    ds_read_b128 v[36:39], v48 offset:7168
    s_add_u32 s41, s40, 0
    s_waitcnt lgkmcnt(7)
    buffer_store_dwordx4 v[8:11], v7, s[28:31], s41 offen sc1
    s_add_u32 s41, s40, 14336
    s_waitcnt lgkmcnt(6)
    buffer_store_dwordx4 v[12:15], v7, s[28:31], s41 offen sc1
    s_add_u32 s41, s40, 28672
    s_waitcnt lgkmcnt(5)
    buffer_store_dwordx4 v[16:19], v7, s[28:31], s41 offen sc1
    s_add_u32 s41, s40, 43008
    s_waitcnt lgkmcnt(4)
    buffer_store_dwordx4 v[20:23], v7, s[28:31], s41 offen sc1
    s_add_u32 s41, s40, 1024
    s_waitcnt lgkmcnt(3)
    buffer_store_dwordx4 v[24:27], v7, s[28:31], s41 offen sc1
    s_add_u32 s41, s40, 15360
    s_waitcnt lgkmcnt(2)
    buffer_store_dwordx4 v[28:31], v7, s[28:31], s41 offen sc1
    s_add_u32 s41, s40, 29696
    s_waitcnt lgkmcnt(1)
    buffer_store_dwordx4 v[32:35], v7, s[28:31], s41 offen sc1
    s_add_u32 s41, s40, 44032
    s_waitcnt lgkmcnt(0)
    buffer_store_dwordx4 v[36:39], v7, s[28:31], s41 offen sc1
L_prep_end_3:
    s_endpgm
L_k2_wo:
    s_mov_b32 s24, s8
    s_and_b32 s25, s9, 0xffff
    s_mov_b32 s26, 401408
    s_mov_b32 s27, 0x00020000
    s_add_u32 s28, s20, 3670016
    s_addc_u32 s29, s21, 0
    s_and_b32 s29, s29, 0xffff
    s_mov_b32 s30, 458752
    s_mov_b32 s31, 0x00020000
    v_lshrrev_b32 v1, 6, v0
    s_nop 0
    v_readfirstlane_b32 s37, v1
    s_sub_u32 s3, s2, 192
    s_lshl_b32 s3, s3, 3
    s_add_u32 s3, s3, s37
    s_cmp_ge_u32 s3, 56
    s_cbranch_scc1 L_prep_end_4
    s_mul_i32 s38, s3, 37
    s_lshr_b32 s38, s38, 8
    s_mul_i32 s39, s38, 7
    s_sub_u32 s39, s3, s39
    v_and_b32 v1, 63, v0
    v_lshrrev_b32 v2, 3, v1
    v_and_b32 v3, 7, v1
    s_lshl_b32 s40, s38, 3
    v_add_u32 v4, s40, v2
    v_lshrrev_b32 v5, 2, v4
    v_and_b32 v6, 3, v4
    v_mul_u32_u24 v5, 28, v5
    v_lshl_add_u32 v4, v6, 3, v5
    v_mul_u32_u24 v4, 896, v4
    s_lshl_b32 s40, s39, 3
    v_add_u32 v7, s40, v3
    v_lshl_add_u32 v4, v7, 4, v4
    s_mov_b32 s34, 0
    buffer_load_dwordx4 v[8:11], v4, s[24:27], s34 offen
    s_mov_b32 s34, 896
    buffer_load_dwordx4 v[12:15], v4, s[24:27], s34 offen
    s_mov_b32 s34, 1792
    buffer_load_dwordx4 v[16:19], v4, s[24:27], s34 offen
    s_mov_b32 s34, 2688
    buffer_load_dwordx4 v[20:23], v4, s[24:27], s34 offen
    s_mov_b32 s34, 3584
    buffer_load_dwordx4 v[24:27], v4, s[24:27], s34 offen
    s_mov_b32 s34, 4480
    buffer_load_dwordx4 v[28:31], v4, s[24:27], s34 offen
    s_mov_b32 s34, 5376
    buffer_load_dwordx4 v[32:35], v4, s[24:27], s34 offen
    s_mov_b32 s34, 6272
    buffer_load_dwordx4 v[36:39], v4, s[24:27], s34 offen
    v_lshrrev_b32 v5, 2, v2
    v_lshlrev_b32 v5, 12, v5
    v_lshrrev_b32 v7, 1, v3
    v_lshl_add_u32 v5, v7, 10, v5
    v_and_b32 v7, 3, v2
    v_lshl_add_u32 v5, v7, 8, v5
    v_and_b32 v7, 1, v3
    v_lshl_add_u32 v5, v7, 7, v5
    s_lshl_b32 s40, s37, 13
    v_add_u32 v5, s40, v5
    v_lshlrev_b32 v7, 4, v1
    v_add_u32 v48, s40, v7
    s_mov_b32 s35, 0x05040100
    s_mov_b32 s36, 0x07060302
    s_lshl_b32 s40, s39, 2
    s_mul_i32 s40, s40, 16
    s_lshl_b32 s41, s38, 1
    s_add_u32 s40, s40, s41
    s_lshl_b32 s40, s40, 10
    s_waitcnt vmcnt(0)
    v_cmp_eq_u32 vcc, 3, v6
    s_nop 1
    v_cndmask_b32_e64 v24, v24, 0, vcc
    v_cndmask_b32_e64 v25, v25, 0, vcc
    v_cndmask_b32_e64 v26, v26, 0, vcc
    v_cndmask_b32_e64 v27, v27, 0, vcc
    v_cndmask_b32_e64 v28, v28, 0, vcc
    v_cndmask_b32_e64 v29, v29, 0, vcc
    v_cndmask_b32_e64 v30, v30, 0, vcc
    v_cndmask_b32_e64 v31, v31, 0, vcc
    v_cndmask_b32_e64 v32, v32, 0, vcc
    v_cndmask_b32_e64 v33, v33, 0, vcc
    v_cndmask_b32_e64 v34, v34, 0, vcc
    v_cndmask_b32_e64 v35, v35, 0, vcc
    v_cndmask_b32_e64 v36, v36, 0, vcc
    v_cndmask_b32_e64 v37, v37, 0, vcc
    v_cndmask_b32_e64 v38, v38, 0, vcc
    v_cndmask_b32_e64 v39, v39, 0, vcc
    v_perm_b32 v40, v12, v8, s35
    v_perm_b32 v41, v20, v16, s35
    v_perm_b32 v42, v28, v24, s35
    v_perm_b32 v43, v36, v32, s35
    ds_write_b128 v5, v[40:43] offset:0
    v_perm_b32 v44, v12, v8, s36
    v_perm_b32 v45, v20, v16, s36
    v_perm_b32 v46, v28, v24, s36
    v_perm_b32 v47, v36, v32, s36
    ds_write_b128 v5, v[44:47] offset:16
    v_perm_b32 v40, v13, v9, s35
    v_perm_b32 v41, v21, v17, s35
    v_perm_b32 v42, v29, v25, s35
    v_perm_b32 v43, v37, v33, s35
    ds_write_b128 v5, v[40:43] offset:32
    v_perm_b32 v44, v13, v9, s36
    v_perm_b32 v45, v21, v17, s36
    v_perm_b32 v46, v29, v25, s36
    v_perm_b32 v47, v37, v33, s36
    ds_write_b128 v5, v[44:47] offset:48
    v_perm_b32 v40, v14, v10, s35
    v_perm_b32 v41, v22, v18, s35
    v_perm_b32 v42, v30, v26, s35
    v_perm_b32 v43, v38, v34, s35
    ds_write_b128 v5, v[40:43] offset:64
    v_perm_b32 v44, v14, v10, s36
    v_perm_b32 v45, v22, v18, s36
    v_perm_b32 v46, v30, v26, s36
    v_perm_b32 v47, v38, v34, s36
    ds_write_b128 v5, v[44:47] offset:80
    v_perm_b32 v40, v15, v11, s35
    v_perm_b32 v41, v23, v19, s35
    v_perm_b32 v42, v31, v27, s35
    v_perm_b32 v43, v39, v35, s35
    ds_write_b128 v5, v[40:43] offset:96
    v_perm_b32 v44, v15, v11, s36
    v_perm_b32 v45, v23, v19, s36
    v_perm_b32 v46, v31, v27, s36
    v_perm_b32 v47, v39, v35, s36
    ds_write_b128 v5, v[44:47] offset:112
    s_waitcnt lgkmcnt(0)
    ds_read_b128 v[8:11], v48 offset:0
    ds_read_b128 v[12:15], v48 offset:1024
    ds_read_b128 v[16:19], v48 offset:2048
    ds_read_b128 v[20:23], v48 offset:3072
    ds_read_b128 v[24:27], v48 offset:4096
    ds_read_b128 v[28:31], v48 offset:5120
    ds_read_b128 v[32:35], v48 offset:6144
    ds_read_b128 v[36:39], v48 offset:7168
    s_add_u32 s41, s40, 0
    s_waitcnt lgkmcnt(7)
    buffer_store_dwordx4 v[8:11], v7, s[28:31], s41 offen sc1
    s_add_u32 s41, s40, 16384
    s_waitcnt lgkmcnt(6)
    buffer_store_dwordx4 v[12:15], v7, s[28:31], s41 offen sc1
    s_add_u32 s41, s40, 32768
    s_waitcnt lgkmcnt(5)
    buffer_store_dwordx4 v[16:19], v7, s[28:31], s41 offen sc1
    s_add_u32 s41, s40, 49152
    s_waitcnt lgkmcnt(4)
    buffer_store_dwordx4 v[20:23], v7, s[28:31], s41 offen sc1
    s_add_u32 s41, s40, 1024
    s_waitcnt lgkmcnt(3)
    buffer_store_dwordx4 v[24:27], v7, s[28:31], s41 offen sc1
    s_add_u32 s41, s40, 17408
    s_waitcnt lgkmcnt(2)
    buffer_store_dwordx4 v[28:31], v7, s[28:31], s41 offen sc1
    s_add_u32 s41, s40, 33792
    s_waitcnt lgkmcnt(1)
    buffer_store_dwordx4 v[32:35], v7, s[28:31], s41 offen sc1
    s_add_u32 s41, s40, 50176
    s_waitcnt lgkmcnt(0)
    buffer_store_dwordx4 v[36:39], v7, s[28:31], s41 offen sc1
L_prep_end_4:
    s_endpgm
L_k2_gemm:
    v_lshrrev_b32 v1, 6, v0
    s_nop 0
    v_readfirstlane_b32 s33, v1
    s_bfe_u32 s34, s2, 0x20001
    s_lshl_b32 s34, s34, 3
    s_bfe_u32 s36, s2, 0x30003
    s_add_u32 s34, s34, s36
    s_lshl_b32 s34, s34, 6
    s_and_b32 s35, s2, 1
    s_mul_i32 s35, s35, 3
    s_lshr_b32 s36, s2, 6
    s_add_u32 s35, s35, s36
    s_lshl_b32 s36, s35, 3
    s_add_u32 s36, s36, s33
    s_lshr_b32 s37, s36, 4
    s_and_b32 s38, s36, 15
    v_mul_u32_u24 v2, 293, v0
    v_lshrrev_b32 v2, 14, v2
    v_mul_u32_u24 v3, 56, v2
    v_sub_u32 v3, v0, v3
    v_add_u32 v4, s34, v2
    v_mul_u32_u24 v4, 896, v4
    v_lshl_add_u32 v4, v3, 4, v4
    v_lshlrev_b32 v5, 5, v3
    v_and_b32 v6, 63, v0
    v_lshlrev_b32 v6, 4, v6
    s_waitcnt lgkmcnt(0)
    s_mov_b32 s4, s20
    s_mov_b32 s5, s21
    s_add_u32 s8, s4, 16384
    s_addc_u32 s9, s5, 0
    s_and_b32 s9, s9, 0xffff
    s_mov_b32 s10, 1835008
    s_mov_b32 s11, 0x00020000
    s_add_u32 s12, s4, 2097152
    s_addc_u32 s13, s5, 0
    s_and_b32 s13, s13, 0xffff
    s_mov_b32 s14, 1376256
    s_mov_b32 s15, 0x00020000
    s_mov_b32 s16, s4
    s_and_b32 s17, s5, 0xffff
    s_mov_b32 s18, 10752
    s_mov_b32 s19, 0x00020000
    s_lshl_b32 s39, s37, 21
    s_add_u32 s39, s39, 8388608
    s_add_u32 s20, s4, s39
    s_addc_u32 s21, s5, 0
    s_and_b32 s21, s21, 0xffff
    s_mov_b32 s22, 2097152
    s_mov_b32 s23, 0x00020000
    v_cmp_gt_u32 vcc, 448, v0
    s_mov_b64 s[40:41], vcc
    s_mov_b64 exec, vcc
    buffer_load_dwordx4 v[16:19], v5, s[16:19], 0 offen
    buffer_load_dwordx4 v[20:23], v5, s[16:19], 0 offen offset:16
    buffer_load_dwordx4 v[24:27], v5, s[16:19], 0 offen offset:1792
    buffer_load_dwordx4 v[28:31], v5, s[16:19], 0 offen offset:1808
    s_mov_b32 s42, 0
    buffer_load_dwordx4 v[48:51], v4, s[8:11], s42 offen
    s_mov_b32 s42, 7168
    buffer_load_dwordx4 v[52:55], v4, s[8:11], s42 offen
    s_mov_b32 s42, 14336
    buffer_load_dwordx4 v[56:59], v4, s[8:11], s42 offen
    s_mov_b32 s42, 21504
    buffer_load_dwordx4 v[60:63], v4, s[8:11], s42 offen
    s_mov_b32 s42, 28672
    buffer_load_dwordx4 v[64:67], v4, s[8:11], s42 offen
    s_mov_b32 s42, 35840
    buffer_load_dwordx4 v[68:71], v4, s[8:11], s42 offen
    s_mov_b32 s42, 43008
    buffer_load_dwordx4 v[72:75], v4, s[8:11], s42 offen
    s_mov_b32 s42, 50176
    buffer_load_dwordx4 v[76:79], v4, s[8:11], s42 offen
    s_mov_b64 exec, -1
    s_lshl_b32 s44, s36, 1
    s_mul_i32 s44, s44, 14336
    s_add_u32 s45, s44, 4096
    s_add_u32 s46, s44, 8192
    s_add_u32 s47, s44, 12288
    s_lshl_b32 s48, s36, 1
    s_add_u32 s48, s48, 1
    s_mul_i32 s48, s48, 14336
    s_add_u32 s49, s48, 4096
    s_add_u32 s50, s48, 8192
    s_add_u32 s51, s48, 12288
    buffer_load_dwordx4 a[0:3], v6, s[12:15], s44 offen offset:0
    buffer_load_dwordx4 a[4:7], v6, s[12:15], s48 offen offset:0
    buffer_load_dwordx4 a[8:11], v6, s[12:15], s44 offen offset:1024
    buffer_load_dwordx4 a[12:15], v6, s[12:15], s48 offen offset:1024
    buffer_load_dwordx4 a[16:19], v6, s[12:15], s44 offen offset:2048
    buffer_load_dwordx4 a[20:23], v6, s[12:15], s48 offen offset:2048
    v_lshrrev_b32 v7, 3, v3
    v_lshlrev_b32 v7, 13, v7
    v_lshl_add_u32 v7, v2, 7, v7
    v_and_b32 v8, 7, v3
    v_xor_b32 v8, v8, v2
    v_lshl_add_u32 v7, v8, 4, v7
    s_waitcnt vmcnt(14)
    v_add_f32 v24, 1.0, v24
    v_add_f32 v25, 1.0, v25
    v_add_f32 v26, 1.0, v26
    v_add_f32 v27, 1.0, v27
    v_add_f32 v28, 1.0, v28
    v_add_f32 v29, 1.0, v29
    v_add_f32 v30, 1.0, v30
    v_add_f32 v31, 1.0, v31
    v_cvt_pk_bf16_f32 v32, v24, v25
    v_cvt_pk_bf16_f32 v33, v26, v27
    v_cvt_pk_bf16_f32 v34, v28, v29
    v_cvt_pk_bf16_f32 v35, v30, v31
    v_lshlrev_b32 v24, 16, v32
    v_and_b32 v25, 0xffff0000, v32
    v_lshlrev_b32 v26, 16, v33
    v_and_b32 v27, 0xffff0000, v33
    v_lshlrev_b32 v28, 16, v34
    v_and_b32 v29, 0xffff0000, v34
    v_lshlrev_b32 v30, 16, v35
    v_and_b32 v31, 0xffff0000, v35
    s_waitcnt vmcnt(13)
    v_lshlrev_b32 v32, 16, v48
    v_and_b32 v33, 0xffff0000, v48
    v_lshlrev_b32 v34, 16, v49
    v_and_b32 v35, 0xffff0000, v49
    v_lshlrev_b32 v36, 16, v50
    v_and_b32 v37, 0xffff0000, v50
    v_lshlrev_b32 v38, 16, v51
    v_and_b32 v39, 0xffff0000, v51
    v_pk_fma_f32 v[32:33], v[32:33], v[24:25], v[16:17]
    v_pk_fma_f32 v[34:35], v[34:35], v[26:27], v[18:19]
    v_pk_fma_f32 v[36:37], v[36:37], v[28:29], v[20:21]
    v_pk_fma_f32 v[38:39], v[38:39], v[30:31], v[22:23]
    v_cvt_pk_bf16_f32 v48, v32, v33
    v_cvt_pk_bf16_f32 v49, v34, v35
    v_cvt_pk_bf16_f32 v50, v36, v37
    v_cvt_pk_bf16_f32 v51, v38, v39
    s_mov_b64 exec, s[40:41]
    ds_write_b128 v7, v[48:51] offset:0
    s_mov_b64 exec, -1
    buffer_load_dwordx4 a[24:27], v6, s[12:15], s44 offen offset:3072
    s_waitcnt vmcnt(13)
    v_lshlrev_b32 v32, 16, v52
    v_and_b32 v33, 0xffff0000, v52
    v_lshlrev_b32 v34, 16, v53
    v_and_b32 v35, 0xffff0000, v53
    v_lshlrev_b32 v36, 16, v54
    v_and_b32 v37, 0xffff0000, v54
    v_lshlrev_b32 v38, 16, v55
    v_and_b32 v39, 0xffff0000, v55
    v_pk_fma_f32 v[32:33], v[32:33], v[24:25], v[16:17]
    v_pk_fma_f32 v[34:35], v[34:35], v[26:27], v[18:19]
    v_pk_fma_f32 v[36:37], v[36:37], v[28:29], v[20:21]
    v_pk_fma_f32 v[38:39], v[38:39], v[30:31], v[22:23]
    v_cvt_pk_bf16_f32 v52, v32, v33
    v_cvt_pk_bf16_f32 v53, v34, v35
    v_cvt_pk_bf16_f32 v54, v36, v37
    v_cvt_pk_bf16_f32 v55, v38, v39
    s_mov_b64 exec, s[40:41]
    ds_write_b128 v7, v[52:55] offset:1024
    s_mov_b64 exec, -1
    buffer_load_dwordx4 a[28:31], v6, s[12:15], s48 offen offset:3072
    s_waitcnt vmcnt(13)
    v_lshlrev_b32 v32, 16, v56
    v_and_b32 v33, 0xffff0000, v56
    v_lshlrev_b32 v34, 16, v57
    v_and_b32 v35, 0xffff0000, v57
    v_lshlrev_b32 v36, 16, v58
    v_and_b32 v37, 0xffff0000, v58
    v_lshlrev_b32 v38, 16, v59
    v_and_b32 v39, 0xffff0000, v59
    v_pk_fma_f32 v[32:33], v[32:33], v[24:25], v[16:17]
    v_pk_fma_f32 v[34:35], v[34:35], v[26:27], v[18:19]
    v_pk_fma_f32 v[36:37], v[36:37], v[28:29], v[20:21]
    v_pk_fma_f32 v[38:39], v[38:39], v[30:31], v[22:23]
    v_cvt_pk_bf16_f32 v56, v32, v33
    v_cvt_pk_bf16_f32 v57, v34, v35
    v_cvt_pk_bf16_f32 v58, v36, v37
    v_cvt_pk_bf16_f32 v59, v38, v39
    s_mov_b64 exec, s[40:41]
    ds_write_b128 v7, v[56:59] offset:2048
    s_mov_b64 exec, -1
    buffer_load_dwordx4 a[32:35], v6, s[12:15], s45 offen offset:0
    s_waitcnt vmcnt(13)
    v_lshlrev_b32 v32, 16, v60
    v_and_b32 v33, 0xffff0000, v60
    v_lshlrev_b32 v34, 16, v61
    v_and_b32 v35, 0xffff0000, v61
    v_lshlrev_b32 v36, 16, v62
    v_and_b32 v37, 0xffff0000, v62
    v_lshlrev_b32 v38, 16, v63
    v_and_b32 v39, 0xffff0000, v63
    v_pk_fma_f32 v[32:33], v[32:33], v[24:25], v[16:17]
    v_pk_fma_f32 v[34:35], v[34:35], v[26:27], v[18:19]
    v_pk_fma_f32 v[36:37], v[36:37], v[28:29], v[20:21]
    v_pk_fma_f32 v[38:39], v[38:39], v[30:31], v[22:23]
    v_cvt_pk_bf16_f32 v60, v32, v33
    v_cvt_pk_bf16_f32 v61, v34, v35
    v_cvt_pk_bf16_f32 v62, v36, v37
    v_cvt_pk_bf16_f32 v63, v38, v39
    s_mov_b64 exec, s[40:41]
    ds_write_b128 v7, v[60:63] offset:3072
    s_mov_b64 exec, -1
    buffer_load_dwordx4 a[36:39], v6, s[12:15], s49 offen offset:0
    s_waitcnt vmcnt(13)
    v_lshlrev_b32 v32, 16, v64
    v_and_b32 v33, 0xffff0000, v64
    v_lshlrev_b32 v34, 16, v65
    v_and_b32 v35, 0xffff0000, v65
    v_lshlrev_b32 v36, 16, v66
    v_and_b32 v37, 0xffff0000, v66
    v_lshlrev_b32 v38, 16, v67
    v_and_b32 v39, 0xffff0000, v67
    v_pk_fma_f32 v[32:33], v[32:33], v[24:25], v[16:17]
    v_pk_fma_f32 v[34:35], v[34:35], v[26:27], v[18:19]
    v_pk_fma_f32 v[36:37], v[36:37], v[28:29], v[20:21]
    v_pk_fma_f32 v[38:39], v[38:39], v[30:31], v[22:23]
    v_cvt_pk_bf16_f32 v64, v32, v33
    v_cvt_pk_bf16_f32 v65, v34, v35
    v_cvt_pk_bf16_f32 v66, v36, v37
    v_cvt_pk_bf16_f32 v67, v38, v39
    s_mov_b64 exec, s[40:41]
    ds_write_b128 v7, v[64:67] offset:4096
    s_mov_b64 exec, -1
    buffer_load_dwordx4 a[40:43], v6, s[12:15], s45 offen offset:1024
    s_waitcnt vmcnt(13)
    v_lshlrev_b32 v32, 16, v68
    v_and_b32 v33, 0xffff0000, v68
    v_lshlrev_b32 v34, 16, v69
    v_and_b32 v35, 0xffff0000, v69
    v_lshlrev_b32 v36, 16, v70
    v_and_b32 v37, 0xffff0000, v70
    v_lshlrev_b32 v38, 16, v71
    v_and_b32 v39, 0xffff0000, v71
    v_pk_fma_f32 v[32:33], v[32:33], v[24:25], v[16:17]
    v_pk_fma_f32 v[34:35], v[34:35], v[26:27], v[18:19]
    v_pk_fma_f32 v[36:37], v[36:37], v[28:29], v[20:21]
    v_pk_fma_f32 v[38:39], v[38:39], v[30:31], v[22:23]
    v_cvt_pk_bf16_f32 v68, v32, v33
    v_cvt_pk_bf16_f32 v69, v34, v35
    v_cvt_pk_bf16_f32 v70, v36, v37
    v_cvt_pk_bf16_f32 v71, v38, v39
    s_mov_b64 exec, s[40:41]
    ds_write_b128 v7, v[68:71] offset:5120
    s_mov_b64 exec, -1
    buffer_load_dwordx4 a[44:47], v6, s[12:15], s49 offen offset:1024
    s_waitcnt vmcnt(13)
    v_lshlrev_b32 v32, 16, v72
    v_and_b32 v33, 0xffff0000, v72
    v_lshlrev_b32 v34, 16, v73
    v_and_b32 v35, 0xffff0000, v73
    v_lshlrev_b32 v36, 16, v74
    v_and_b32 v37, 0xffff0000, v74
    v_lshlrev_b32 v38, 16, v75
    v_and_b32 v39, 0xffff0000, v75
    v_pk_fma_f32 v[32:33], v[32:33], v[24:25], v[16:17]
    v_pk_fma_f32 v[34:35], v[34:35], v[26:27], v[18:19]
    v_pk_fma_f32 v[36:37], v[36:37], v[28:29], v[20:21]
    v_pk_fma_f32 v[38:39], v[38:39], v[30:31], v[22:23]
    v_cvt_pk_bf16_f32 v72, v32, v33
    v_cvt_pk_bf16_f32 v73, v34, v35
    v_cvt_pk_bf16_f32 v74, v36, v37
    v_cvt_pk_bf16_f32 v75, v38, v39
    s_mov_b64 exec, s[40:41]
    ds_write_b128 v7, v[72:75] offset:6144
    s_mov_b64 exec, -1
    buffer_load_dwordx4 a[48:51], v6, s[12:15], s45 offen offset:2048
    s_waitcnt vmcnt(13)
    v_lshlrev_b32 v32, 16, v76
    v_and_b32 v33, 0xffff0000, v76
    v_lshlrev_b32 v34, 16, v77
    v_and_b32 v35, 0xffff0000, v77
    v_lshlrev_b32 v36, 16, v78
    v_and_b32 v37, 0xffff0000, v78
    v_lshlrev_b32 v38, 16, v79
    v_and_b32 v39, 0xffff0000, v79
    v_pk_fma_f32 v[32:33], v[32:33], v[24:25], v[16:17]
    v_pk_fma_f32 v[34:35], v[34:35], v[26:27], v[18:19]
    v_pk_fma_f32 v[36:37], v[36:37], v[28:29], v[20:21]
    v_pk_fma_f32 v[38:39], v[38:39], v[30:31], v[22:23]
    v_cvt_pk_bf16_f32 v76, v32, v33
    v_cvt_pk_bf16_f32 v77, v34, v35
    v_cvt_pk_bf16_f32 v78, v36, v37
    v_cvt_pk_bf16_f32 v79, v38, v39
    s_mov_b64 exec, s[40:41]
    ds_write_b128 v7, v[76:79] offset:7168
    s_mov_b64 exec, -1
    buffer_load_dwordx4 a[52:55], v6, s[12:15], s49 offen offset:2048
    buffer_load_dwordx4 a[56:59], v6, s[12:15], s45 offen offset:3072
    buffer_load_dwordx4 a[60:63], v6, s[12:15], s49 offen offset:3072
    buffer_load_dwordx4 a[64:67], v6, s[12:15], s46 offen offset:0
    buffer_load_dwordx4 a[68:71], v6, s[12:15], s50 offen offset:0
    v_and_b32 v8, 15, v0
    v_bfe_u32 v9, v0, 4, 2
    v_and_b32 v12, 7, v8
    v_xor_b32 v13, v12, v9
    v_lshlrev_b32 v14, 7, v8
    v_lshl_add_u32 v10, v13, 4, v14
    v_xor_b32 v13, 4, v13
    v_lshl_add_u32 v11, v13, 4, v14
    s_waitcnt lgkmcnt(0)
    s_barrier
    s_cmp_eq_u32 s37, 2
    s_cbranch_scc1 L_k2_v
    ds_read_b128 v[80:83], v10 offset:0
    ds_read_b128 v[84:87], v10 offset:2048
    ds_read_b128 v[88:91], v10 offset:4096
    ds_read_b128 v[92:95], v10 offset:6144
    buffer_load_dwordx4 a[72:75], v6, s[12:15], s46 offen offset:1024
    buffer_load_dwordx4 a[76:79], v6, s[12:15], s50 offen offset:1024
    ds_read_b128 v[96:99], v11 offset:0
    ds_read_b128 v[100:103], v11 offset:2048
    ds_read_b128 v[104:107], v11 offset:4096
    ds_read_b128 v[108:111], v11 offset:6144
    s_waitcnt vmcnt(18) lgkmcnt(4)
    v_mfma_f32_16x16x32_bf16 v[48:51], a[0:3], v[80:83], 0
    v_mfma_f32_16x16x32_bf16 v[52:55], a[0:3], v[84:87], 0
    v_mfma_f32_16x16x32_bf16 v[56:59], a[0:3], v[88:91], 0
    v_mfma_f32_16x16x32_bf16 v[60:63], a[0:3], v[92:95], 0
    v_mfma_f32_16x16x32_bf16 v[64:67], a[4:7], v[80:83], 0
    v_mfma_f32_16x16x32_bf16 v[68:71], a[4:7], v[84:87], 0
    v_mfma_f32_16x16x32_bf16 v[72:75], a[4:7], v[88:91], 0
    v_mfma_f32_16x16x32_bf16 v[76:79], a[4:7], v[92:95], 0
    buffer_load_dwordx4 a[80:83], v6, s[12:15], s46 offen offset:2048
    buffer_load_dwordx4 a[84:87], v6, s[12:15], s50 offen offset:2048
    ds_read_b128 v[80:83], v10 offset:8192
    ds_read_b128 v[84:87], v10 offset:10240
    ds_read_b128 v[88:91], v10 offset:12288
    ds_read_b128 v[92:95], v10 offset:14336
    s_waitcnt vmcnt(18) lgkmcnt(4)
    v_mfma_f32_16x16x32_bf16 v[48:51], a[8:11], v[96:99], v[48:51]
    v_mfma_f32_16x16x32_bf16 v[52:55], a[8:11], v[100:103], v[52:55]
    v_mfma_f32_16x16x32_bf16 v[56:59], a[8:11], v[104:107], v[56:59]
    v_mfma_f32_16x16x32_bf16 v[60:63], a[8:11], v[108:111], v[60:63]
    v_mfma_f32_16x16x32_bf16 v[64:67], a[12:15], v[96:99], v[64:67]
    v_mfma_f32_16x16x32_bf16 v[68:71], a[12:15], v[100:103], v[68:71]
    v_mfma_f32_16x16x32_bf16 v[72:75], a[12:15], v[104:107], v[72:75]
    v_mfma_f32_16x16x32_bf16 v[76:79], a[12:15], v[108:111], v[76:79]
    buffer_load_dwordx4 a[88:91], v6, s[12:15], s46 offen offset:3072
    buffer_load_dwordx4 a[92:95], v6, s[12:15], s50 offen offset:3072
    ds_read_b128 v[96:99], v11 offset:8192
    ds_read_b128 v[100:103], v11 offset:10240
    ds_read_b128 v[104:107], v11 offset:12288
    ds_read_b128 v[108:111], v11 offset:14336
    s_waitcnt vmcnt(18) lgkmcnt(4)
    v_mfma_f32_16x16x32_bf16 v[48:51], a[16:19], v[80:83], v[48:51]
    v_mfma_f32_16x16x32_bf16 v[52:55], a[16:19], v[84:87], v[52:55]
    v_mfma_f32_16x16x32_bf16 v[56:59], a[16:19], v[88:91], v[56:59]
    v_mfma_f32_16x16x32_bf16 v[60:63], a[16:19], v[92:95], v[60:63]
    v_mfma_f32_16x16x32_bf16 v[64:67], a[20:23], v[80:83], v[64:67]
    v_mfma_f32_16x16x32_bf16 v[68:71], a[20:23], v[84:87], v[68:71]
    v_mfma_f32_16x16x32_bf16 v[72:75], a[20:23], v[88:91], v[72:75]
    v_mfma_f32_16x16x32_bf16 v[76:79], a[20:23], v[92:95], v[76:79]
    buffer_load_dwordx4 a[96:99], v6, s[12:15], s47 offen offset:0
    buffer_load_dwordx4 a[100:103], v6, s[12:15], s51 offen offset:0
    ds_read_b128 v[80:83], v10 offset:16384
    ds_read_b128 v[84:87], v10 offset:18432
    ds_read_b128 v[88:91], v10 offset:20480
    ds_read_b128 v[92:95], v10 offset:22528
    s_waitcnt vmcnt(18) lgkmcnt(4)
    v_mfma_f32_16x16x32_bf16 v[48:51], a[24:27], v[96:99], v[48:51]
    v_mfma_f32_16x16x32_bf16 v[52:55], a[24:27], v[100:103], v[52:55]
    v_mfma_f32_16x16x32_bf16 v[56:59], a[24:27], v[104:107], v[56:59]
    v_mfma_f32_16x16x32_bf16 v[60:63], a[24:27], v[108:111], v[60:63]
    v_mfma_f32_16x16x32_bf16 v[64:67], a[28:31], v[96:99], v[64:67]
    v_mfma_f32_16x16x32_bf16 v[68:71], a[28:31], v[100:103], v[68:71]
    v_mfma_f32_16x16x32_bf16 v[72:75], a[28:31], v[104:107], v[72:75]
    v_mfma_f32_16x16x32_bf16 v[76:79], a[28:31], v[108:111], v[76:79]
    buffer_load_dwordx4 a[104:107], v6, s[12:15], s47 offen offset:1024
    buffer_load_dwordx4 a[108:111], v6, s[12:15], s51 offen offset:1024
    ds_read_b128 v[96:99], v11 offset:16384
    ds_read_b128 v[100:103], v11 offset:18432
    ds_read_b128 v[104:107], v11 offset:20480
    ds_read_b128 v[108:111], v11 offset:22528
    s_waitcnt vmcnt(18) lgkmcnt(4)
    v_mfma_f32_16x16x32_bf16 v[48:51], a[32:35], v[80:83], v[48:51]
    v_mfma_f32_16x16x32_bf16 v[52:55], a[32:35], v[84:87], v[52:55]
    v_mfma_f32_16x16x32_bf16 v[56:59], a[32:35], v[88:91], v[56:59]
    v_mfma_f32_16x16x32_bf16 v[60:63], a[32:35], v[92:95], v[60:63]
    v_mfma_f32_16x16x32_bf16 v[64:67], a[36:39], v[80:83], v[64:67]
    v_mfma_f32_16x16x32_bf16 v[68:71], a[36:39], v[84:87], v[68:71]
    v_mfma_f32_16x16x32_bf16 v[72:75], a[36:39], v[88:91], v[72:75]
    v_mfma_f32_16x16x32_bf16 v[76:79], a[36:39], v[92:95], v[76:79]
    ds_read_b128 v[80:83], v10 offset:24576
    ds_read_b128 v[84:87], v10 offset:26624
    ds_read_b128 v[88:91], v10 offset:28672
    ds_read_b128 v[92:95], v10 offset:30720
    s_waitcnt vmcnt(16) lgkmcnt(4)
    v_mfma_f32_16x16x32_bf16 v[48:51], a[40:43], v[96:99], v[48:51]
    v_mfma_f32_16x16x32_bf16 v[52:55], a[40:43], v[100:103], v[52:55]
    v_mfma_f32_16x16x32_bf16 v[56:59], a[40:43], v[104:107], v[56:59]
    v_mfma_f32_16x16x32_bf16 v[60:63], a[40:43], v[108:111], v[60:63]
    v_mfma_f32_16x16x32_bf16 v[64:67], a[44:47], v[96:99], v[64:67]
    v_mfma_f32_16x16x32_bf16 v[68:71], a[44:47], v[100:103], v[68:71]
    v_mfma_f32_16x16x32_bf16 v[72:75], a[44:47], v[104:107], v[72:75]
    v_mfma_f32_16x16x32_bf16 v[76:79], a[44:47], v[108:111], v[76:79]
    ds_read_b128 v[96:99], v11 offset:24576
    ds_read_b128 v[100:103], v11 offset:26624
    ds_read_b128 v[104:107], v11 offset:28672
    ds_read_b128 v[108:111], v11 offset:30720
    s_waitcnt vmcnt(14) lgkmcnt(4)
    v_mfma_f32_16x16x32_bf16 v[48:51], a[48:51], v[80:83], v[48:51]
    v_mfma_f32_16x16x32_bf16 v[52:55], a[48:51], v[84:87], v[52:55]
    v_mfma_f32_16x16x32_bf16 v[56:59], a[48:51], v[88:91], v[56:59]
    v_mfma_f32_16x16x32_bf16 v[60:63], a[48:51], v[92:95], v[60:63]
    v_mfma_f32_16x16x32_bf16 v[64:67], a[52:55], v[80:83], v[64:67]
    v_mfma_f32_16x16x32_bf16 v[68:71], a[52:55], v[84:87], v[68:71]
    v_mfma_f32_16x16x32_bf16 v[72:75], a[52:55], v[88:91], v[72:75]
    v_mfma_f32_16x16x32_bf16 v[76:79], a[52:55], v[92:95], v[76:79]
    ds_read_b128 v[80:83], v10 offset:32768
    ds_read_b128 v[84:87], v10 offset:34816
    ds_read_b128 v[88:91], v10 offset:36864
    ds_read_b128 v[92:95], v10 offset:38912
    s_waitcnt vmcnt(12) lgkmcnt(4)
    v_mfma_f32_16x16x32_bf16 v[48:51], a[56:59], v[96:99], v[48:51]
    v_mfma_f32_16x16x32_bf16 v[52:55], a[56:59], v[100:103], v[52:55]
    v_mfma_f32_16x16x32_bf16 v[56:59], a[56:59], v[104:107], v[56:59]
    v_mfma_f32_16x16x32_bf16 v[60:63], a[56:59], v[108:111], v[60:63]
    v_mfma_f32_16x16x32_bf16 v[64:67], a[60:63], v[96:99], v[64:67]
    v_mfma_f32_16x16x32_bf16 v[68:71], a[60:63], v[100:103], v[68:71]
    v_mfma_f32_16x16x32_bf16 v[72:75], a[60:63], v[104:107], v[72:75]
    v_mfma_f32_16x16x32_bf16 v[76:79], a[60:63], v[108:111], v[76:79]
    ds_read_b128 v[96:99], v11 offset:32768
    ds_read_b128 v[100:103], v11 offset:34816
    ds_read_b128 v[104:107], v11 offset:36864
    ds_read_b128 v[108:111], v11 offset:38912
    s_waitcnt vmcnt(10) lgkmcnt(4)
    v_mfma_f32_16x16x32_bf16 v[48:51], a[64:67], v[80:83], v[48:51]
    v_mfma_f32_16x16x32_bf16 v[52:55], a[64:67], v[84:87], v[52:55]
    v_mfma_f32_16x16x32_bf16 v[56:59], a[64:67], v[88:91], v[56:59]
    v_mfma_f32_16x16x32_bf16 v[60:63], a[64:67], v[92:95], v[60:63]
    v_mfma_f32_16x16x32_bf16 v[64:67], a[68:71], v[80:83], v[64:67]
    v_mfma_f32_16x16x32_bf16 v[68:71], a[68:71], v[84:87], v[68:71]
    v_mfma_f32_16x16x32_bf16 v[72:75], a[68:71], v[88:91], v[72:75]
    v_mfma_f32_16x16x32_bf16 v[76:79], a[68:71], v[92:95], v[76:79]
    ds_read_b128 v[80:83], v10 offset:40960
    ds_read_b128 v[84:87], v10 offset:43008
    ds_read_b128 v[88:91], v10 offset:45056
    ds_read_b128 v[92:95], v10 offset:47104
    s_waitcnt vmcnt(8) lgkmcnt(4)
    v_mfma_f32_16x16x32_bf16 v[48:51], a[72:75], v[96:99], v[48:51]
    v_mfma_f32_16x16x32_bf16 v[52:55], a[72:75], v[100:103], v[52:55]
    v_mfma_f32_16x16x32_bf16 v[56:59], a[72:75], v[104:107], v[56:59]
    v_mfma_f32_16x16x32_bf16 v[60:63], a[72:75], v[108:111], v[60:63]
    v_mfma_f32_16x16x32_bf16 v[64:67], a[76:79], v[96:99], v[64:67]
    v_mfma_f32_16x16x32_bf16 v[68:71], a[76:79], v[100:103], v[68:71]
    v_mfma_f32_16x16x32_bf16 v[72:75], a[76:79], v[104:107], v[72:75]
    v_mfma_f32_16x16x32_bf16 v[76:79], a[76:79], v[108:111], v[76:79]
    ds_read_b128 v[96:99], v11 offset:40960
    ds_read_b128 v[100:103], v11 offset:43008
    ds_read_b128 v[104:107], v11 offset:45056
    ds_read_b128 v[108:111], v11 offset:47104
    s_waitcnt vmcnt(6) lgkmcnt(4)
    v_mfma_f32_16x16x32_bf16 v[48:51], a[80:83], v[80:83], v[48:51]
    v_mfma_f32_16x16x32_bf16 v[52:55], a[80:83], v[84:87], v[52:55]
    v_mfma_f32_16x16x32_bf16 v[56:59], a[80:83], v[88:91], v[56:59]
    v_mfma_f32_16x16x32_bf16 v[60:63], a[80:83], v[92:95], v[60:63]
    v_mfma_f32_16x16x32_bf16 v[64:67], a[84:87], v[80:83], v[64:67]
    v_mfma_f32_16x16x32_bf16 v[68:71], a[84:87], v[84:87], v[68:71]
    v_mfma_f32_16x16x32_bf16 v[72:75], a[84:87], v[88:91], v[72:75]
    v_mfma_f32_16x16x32_bf16 v[76:79], a[84:87], v[92:95], v[76:79]
    ds_read_b128 v[80:83], v10 offset:49152
    ds_read_b128 v[84:87], v10 offset:51200
    ds_read_b128 v[88:91], v10 offset:53248
    ds_read_b128 v[92:95], v10 offset:55296
    s_waitcnt vmcnt(4) lgkmcnt(4)
    v_mfma_f32_16x16x32_bf16 v[48:51], a[88:91], v[96:99], v[48:51]
    v_mfma_f32_16x16x32_bf16 v[52:55], a[88:91], v[100:103], v[52:55]
    v_mfma_f32_16x16x32_bf16 v[56:59], a[88:91], v[104:107], v[56:59]
    v_mfma_f32_16x16x32_bf16 v[60:63], a[88:91], v[108:111], v[60:63]
    v_mfma_f32_16x16x32_bf16 v[64:67], a[92:95], v[96:99], v[64:67]
    v_mfma_f32_16x16x32_bf16 v[68:71], a[92:95], v[100:103], v[68:71]
    v_mfma_f32_16x16x32_bf16 v[72:75], a[92:95], v[104:107], v[72:75]
    v_mfma_f32_16x16x32_bf16 v[76:79], a[92:95], v[108:111], v[76:79]
    ds_read_b128 v[96:99], v11 offset:49152
    ds_read_b128 v[100:103], v11 offset:51200
    ds_read_b128 v[104:107], v11 offset:53248
    ds_read_b128 v[108:111], v11 offset:55296
    s_waitcnt vmcnt(2) lgkmcnt(4)
    v_mfma_f32_16x16x32_bf16 v[48:51], a[96:99], v[80:83], v[48:51]
    v_mfma_f32_16x16x32_bf16 v[52:55], a[96:99], v[84:87], v[52:55]
    v_mfma_f32_16x16x32_bf16 v[56:59], a[96:99], v[88:91], v[56:59]
    v_mfma_f32_16x16x32_bf16 v[60:63], a[96:99], v[92:95], v[60:63]
    v_mfma_f32_16x16x32_bf16 v[64:67], a[100:103], v[80:83], v[64:67]
    v_mfma_f32_16x16x32_bf16 v[68:71], a[100:103], v[84:87], v[68:71]
    v_mfma_f32_16x16x32_bf16 v[72:75], a[100:103], v[88:91], v[72:75]
    v_mfma_f32_16x16x32_bf16 v[76:79], a[100:103], v[92:95], v[76:79]
    s_waitcnt vmcnt(0) lgkmcnt(0)
    v_mfma_f32_16x16x32_bf16 v[48:51], a[104:107], v[96:99], v[48:51]
    v_mfma_f32_16x16x32_bf16 v[52:55], a[104:107], v[100:103], v[52:55]
    v_mfma_f32_16x16x32_bf16 v[56:59], a[104:107], v[104:107], v[56:59]
    v_mfma_f32_16x16x32_bf16 v[60:63], a[104:107], v[108:111], v[60:63]
    v_mfma_f32_16x16x32_bf16 v[64:67], a[108:111], v[96:99], v[64:67]
    v_mfma_f32_16x16x32_bf16 v[68:71], a[108:111], v[100:103], v[68:71]
    v_mfma_f32_16x16x32_bf16 v[72:75], a[108:111], v[104:107], v[72:75]
    v_mfma_f32_16x16x32_bf16 v[76:79], a[108:111], v[108:111], v[76:79]
    s_lshl_b32 s39, s38, 11
    s_add_u32 s39, s39, s34
    v_add_u32 v12, s39, v8
    v_lshlrev_b32 v12, 6, v12
    v_and_b32 v13, 1, v9
    v_lshl_add_u32 v12, v13, 5, v12
    v_lshrrev_b32 v13, 1, v9
    v_lshl_add_u32 v12, v13, 4, v12
    s_nop 2
    v_cvt_pk_bf16_f32 v16, v48, v49
    v_cvt_pk_bf16_f32 v17, v50, v51
    v_cvt_pk_bf16_f32 v18, v64, v65
    v_cvt_pk_bf16_f32 v19, v66, v67
    s_nop 1
    v_permlane16_swap_b32 v16, v18
    v_permlane16_swap_b32 v17, v19
    buffer_store_dwordx4 v[16:19], v12, s[20:23], 0 offen offset:0 sc1
    v_cvt_pk_bf16_f32 v20, v52, v53
    v_cvt_pk_bf16_f32 v21, v54, v55
    v_cvt_pk_bf16_f32 v22, v68, v69
    v_cvt_pk_bf16_f32 v23, v70, v71
    s_nop 1
    v_permlane16_swap_b32 v20, v22
    v_permlane16_swap_b32 v21, v23
    buffer_store_dwordx4 v[20:23], v12, s[20:23], 0 offen offset:1024 sc1
    v_cvt_pk_bf16_f32 v24, v56, v57
    v_cvt_pk_bf16_f32 v25, v58, v59
    v_cvt_pk_bf16_f32 v26, v72, v73
    v_cvt_pk_bf16_f32 v27, v74, v75
    s_nop 1
    v_permlane16_swap_b32 v24, v26
    v_permlane16_swap_b32 v25, v27
    buffer_store_dwordx4 v[24:27], v12, s[20:23], 0 offen offset:2048 sc1
    v_cvt_pk_bf16_f32 v28, v60, v61
    v_cvt_pk_bf16_f32 v29, v62, v63
    v_cvt_pk_bf16_f32 v30, v76, v77
    v_cvt_pk_bf16_f32 v31, v78, v79
    s_nop 1
    v_permlane16_swap_b32 v28, v30
    v_permlane16_swap_b32 v29, v31
    buffer_store_dwordx4 v[28:31], v12, s[20:23], 0 offen offset:3072 sc1
    s_branch L_k2_exit
L_k2_v:
    ds_read_b128 v[80:83], v10 offset:0
    ds_read_b128 v[84:87], v10 offset:2048
    ds_read_b128 v[88:91], v10 offset:4096
    ds_read_b128 v[92:95], v10 offset:6144
    buffer_load_dwordx4 a[72:75], v6, s[12:15], s46 offen offset:1024
    buffer_load_dwordx4 a[76:79], v6, s[12:15], s50 offen offset:1024
    ds_read_b128 v[96:99], v11 offset:0
    ds_read_b128 v[100:103], v11 offset:2048
    ds_read_b128 v[104:107], v11 offset:4096
    ds_read_b128 v[108:111], v11 offset:6144
    s_waitcnt vmcnt(18) lgkmcnt(4)
    v_mfma_f32_16x16x32_bf16 v[48:51], v[80:83], a[0:3], 0
    v_mfma_f32_16x16x32_bf16 v[52:55], v[84:87], a[0:3], 0
    v_mfma_f32_16x16x32_bf16 v[56:59], v[88:91], a[0:3], 0
    v_mfma_f32_16x16x32_bf16 v[60:63], v[92:95], a[0:3], 0
    v_mfma_f32_16x16x32_bf16 v[64:67], v[80:83], a[4:7], 0
    v_mfma_f32_16x16x32_bf16 v[68:71], v[84:87], a[4:7], 0
    v_mfma_f32_16x16x32_bf16 v[72:75], v[88:91], a[4:7], 0
    v_mfma_f32_16x16x32_bf16 v[76:79], v[92:95], a[4:7], 0
    buffer_load_dwordx4 a[80:83], v6, s[12:15], s46 offen offset:2048
    buffer_load_dwordx4 a[84:87], v6, s[12:15], s50 offen offset:2048
    ds_read_b128 v[80:83], v10 offset:8192
    ds_read_b128 v[84:87], v10 offset:10240
    ds_read_b128 v[88:91], v10 offset:12288
    ds_read_b128 v[92:95], v10 offset:14336
    s_waitcnt vmcnt(18) lgkmcnt(4)
    v_mfma_f32_16x16x32_bf16 v[48:51], v[96:99], a[8:11], v[48:51]
    v_mfma_f32_16x16x32_bf16 v[52:55], v[100:103], a[8:11], v[52:55]
    v_mfma_f32_16x16x32_bf16 v[56:59], v[104:107], a[8:11], v[56:59]
    v_mfma_f32_16x16x32_bf16 v[60:63], v[108:111], a[8:11], v[60:63]
    v_mfma_f32_16x16x32_bf16 v[64:67], v[96:99], a[12:15], v[64:67]
    v_mfma_f32_16x16x32_bf16 v[68:71], v[100:103], a[12:15], v[68:71]
    v_mfma_f32_16x16x32_bf16 v[72:75], v[104:107], a[12:15], v[72:75]
    v_mfma_f32_16x16x32_bf16 v[76:79], v[108:111], a[12:15], v[76:79]
    buffer_load_dwordx4 a[88:91], v6, s[12:15], s46 offen offset:3072
    buffer_load_dwordx4 a[92:95], v6, s[12:15], s50 offen offset:3072
    ds_read_b128 v[96:99], v11 offset:8192
    ds_read_b128 v[100:103], v11 offset:10240
    ds_read_b128 v[104:107], v11 offset:12288
    ds_read_b128 v[108:111], v11 offset:14336
    s_waitcnt vmcnt(18) lgkmcnt(4)
    v_mfma_f32_16x16x32_bf16 v[48:51], v[80:83], a[16:19], v[48:51]
    v_mfma_f32_16x16x32_bf16 v[52:55], v[84:87], a[16:19], v[52:55]
    v_mfma_f32_16x16x32_bf16 v[56:59], v[88:91], a[16:19], v[56:59]
    v_mfma_f32_16x16x32_bf16 v[60:63], v[92:95], a[16:19], v[60:63]
    v_mfma_f32_16x16x32_bf16 v[64:67], v[80:83], a[20:23], v[64:67]
    v_mfma_f32_16x16x32_bf16 v[68:71], v[84:87], a[20:23], v[68:71]
    v_mfma_f32_16x16x32_bf16 v[72:75], v[88:91], a[20:23], v[72:75]
    v_mfma_f32_16x16x32_bf16 v[76:79], v[92:95], a[20:23], v[76:79]
    buffer_load_dwordx4 a[96:99], v6, s[12:15], s47 offen offset:0
    buffer_load_dwordx4 a[100:103], v6, s[12:15], s51 offen offset:0
    ds_read_b128 v[80:83], v10 offset:16384
    ds_read_b128 v[84:87], v10 offset:18432
    ds_read_b128 v[88:91], v10 offset:20480
    ds_read_b128 v[92:95], v10 offset:22528
    s_waitcnt vmcnt(18) lgkmcnt(4)
    v_mfma_f32_16x16x32_bf16 v[48:51], v[96:99], a[24:27], v[48:51]
    v_mfma_f32_16x16x32_bf16 v[52:55], v[100:103], a[24:27], v[52:55]
    v_mfma_f32_16x16x32_bf16 v[56:59], v[104:107], a[24:27], v[56:59]
    v_mfma_f32_16x16x32_bf16 v[60:63], v[108:111], a[24:27], v[60:63]
    v_mfma_f32_16x16x32_bf16 v[64:67], v[96:99], a[28:31], v[64:67]
    v_mfma_f32_16x16x32_bf16 v[68:71], v[100:103], a[28:31], v[68:71]
    v_mfma_f32_16x16x32_bf16 v[72:75], v[104:107], a[28:31], v[72:75]
    v_mfma_f32_16x16x32_bf16 v[76:79], v[108:111], a[28:31], v[76:79]
    buffer_load_dwordx4 a[104:107], v6, s[12:15], s47 offen offset:1024
    buffer_load_dwordx4 a[108:111], v6, s[12:15], s51 offen offset:1024
    ds_read_b128 v[96:99], v11 offset:16384
    ds_read_b128 v[100:103], v11 offset:18432
    ds_read_b128 v[104:107], v11 offset:20480
    ds_read_b128 v[108:111], v11 offset:22528
    s_waitcnt vmcnt(18) lgkmcnt(4)
    v_mfma_f32_16x16x32_bf16 v[48:51], v[80:83], a[32:35], v[48:51]
    v_mfma_f32_16x16x32_bf16 v[52:55], v[84:87], a[32:35], v[52:55]
    v_mfma_f32_16x16x32_bf16 v[56:59], v[88:91], a[32:35], v[56:59]
    v_mfma_f32_16x16x32_bf16 v[60:63], v[92:95], a[32:35], v[60:63]
    v_mfma_f32_16x16x32_bf16 v[64:67], v[80:83], a[36:39], v[64:67]
    v_mfma_f32_16x16x32_bf16 v[68:71], v[84:87], a[36:39], v[68:71]
    v_mfma_f32_16x16x32_bf16 v[72:75], v[88:91], a[36:39], v[72:75]
    v_mfma_f32_16x16x32_bf16 v[76:79], v[92:95], a[36:39], v[76:79]
    ds_read_b128 v[80:83], v10 offset:24576
    ds_read_b128 v[84:87], v10 offset:26624
    ds_read_b128 v[88:91], v10 offset:28672
    ds_read_b128 v[92:95], v10 offset:30720
    s_waitcnt vmcnt(16) lgkmcnt(4)
    v_mfma_f32_16x16x32_bf16 v[48:51], v[96:99], a[40:43], v[48:51]
    v_mfma_f32_16x16x32_bf16 v[52:55], v[100:103], a[40:43], v[52:55]
    v_mfma_f32_16x16x32_bf16 v[56:59], v[104:107], a[40:43], v[56:59]
    v_mfma_f32_16x16x32_bf16 v[60:63], v[108:111], a[40:43], v[60:63]
    v_mfma_f32_16x16x32_bf16 v[64:67], v[96:99], a[44:47], v[64:67]
    v_mfma_f32_16x16x32_bf16 v[68:71], v[100:103], a[44:47], v[68:71]
    v_mfma_f32_16x16x32_bf16 v[72:75], v[104:107], a[44:47], v[72:75]
    v_mfma_f32_16x16x32_bf16 v[76:79], v[108:111], a[44:47], v[76:79]
    ds_read_b128 v[96:99], v11 offset:24576
    ds_read_b128 v[100:103], v11 offset:26624
    ds_read_b128 v[104:107], v11 offset:28672
    ds_read_b128 v[108:111], v11 offset:30720
    s_waitcnt vmcnt(14) lgkmcnt(4)
    v_mfma_f32_16x16x32_bf16 v[48:51], v[80:83], a[48:51], v[48:51]
    v_mfma_f32_16x16x32_bf16 v[52:55], v[84:87], a[48:51], v[52:55]
    v_mfma_f32_16x16x32_bf16 v[56:59], v[88:91], a[48:51], v[56:59]
    v_mfma_f32_16x16x32_bf16 v[60:63], v[92:95], a[48:51], v[60:63]
    v_mfma_f32_16x16x32_bf16 v[64:67], v[80:83], a[52:55], v[64:67]
    v_mfma_f32_16x16x32_bf16 v[68:71], v[84:87], a[52:55], v[68:71]
    v_mfma_f32_16x16x32_bf16 v[72:75], v[88:91], a[52:55], v[72:75]
    v_mfma_f32_16x16x32_bf16 v[76:79], v[92:95], a[52:55], v[76:79]
    ds_read_b128 v[80:83], v10 offset:32768
    ds_read_b128 v[84:87], v10 offset:34816
    ds_read_b128 v[88:91], v10 offset:36864
    ds_read_b128 v[92:95], v10 offset:38912
    s_waitcnt vmcnt(12) lgkmcnt(4)
    v_mfma_f32_16x16x32_bf16 v[48:51], v[96:99], a[56:59], v[48:51]
    v_mfma_f32_16x16x32_bf16 v[52:55], v[100:103], a[56:59], v[52:55]
    v_mfma_f32_16x16x32_bf16 v[56:59], v[104:107], a[56:59], v[56:59]
    v_mfma_f32_16x16x32_bf16 v[60:63], v[108:111], a[56:59], v[60:63]
    v_mfma_f32_16x16x32_bf16 v[64:67], v[96:99], a[60:63], v[64:67]
    v_mfma_f32_16x16x32_bf16 v[68:71], v[100:103], a[60:63], v[68:71]
    v_mfma_f32_16x16x32_bf16 v[72:75], v[104:107], a[60:63], v[72:75]
    v_mfma_f32_16x16x32_bf16 v[76:79], v[108:111], a[60:63], v[76:79]
    ds_read_b128 v[96:99], v11 offset:32768
    ds_read_b128 v[100:103], v11 offset:34816
    ds_read_b128 v[104:107], v11 offset:36864
    ds_read_b128 v[108:111], v11 offset:38912
    s_waitcnt vmcnt(10) lgkmcnt(4)
    v_mfma_f32_16x16x32_bf16 v[48:51], v[80:83], a[64:67], v[48:51]
    v_mfma_f32_16x16x32_bf16 v[52:55], v[84:87], a[64:67], v[52:55]
    v_mfma_f32_16x16x32_bf16 v[56:59], v[88:91], a[64:67], v[56:59]
    v_mfma_f32_16x16x32_bf16 v[60:63], v[92:95], a[64:67], v[60:63]
    v_mfma_f32_16x16x32_bf16 v[64:67], v[80:83], a[68:71], v[64:67]
    v_mfma_f32_16x16x32_bf16 v[68:71], v[84:87], a[68:71], v[68:71]
    v_mfma_f32_16x16x32_bf16 v[72:75], v[88:91], a[68:71], v[72:75]
    v_mfma_f32_16x16x32_bf16 v[76:79], v[92:95], a[68:71], v[76:79]
    ds_read_b128 v[80:83], v10 offset:40960
    ds_read_b128 v[84:87], v10 offset:43008
    ds_read_b128 v[88:91], v10 offset:45056
    ds_read_b128 v[92:95], v10 offset:47104
    s_waitcnt vmcnt(8) lgkmcnt(4)
    v_mfma_f32_16x16x32_bf16 v[48:51], v[96:99], a[72:75], v[48:51]
    v_mfma_f32_16x16x32_bf16 v[52:55], v[100:103], a[72:75], v[52:55]
    v_mfma_f32_16x16x32_bf16 v[56:59], v[104:107], a[72:75], v[56:59]
    v_mfma_f32_16x16x32_bf16 v[60:63], v[108:111], a[72:75], v[60:63]
    v_mfma_f32_16x16x32_bf16 v[64:67], v[96:99], a[76:79], v[64:67]
    v_mfma_f32_16x16x32_bf16 v[68:71], v[100:103], a[76:79], v[68:71]
    v_mfma_f32_16x16x32_bf16 v[72:75], v[104:107], a[76:79], v[72:75]
    v_mfma_f32_16x16x32_bf16 v[76:79], v[108:111], a[76:79], v[76:79]
    ds_read_b128 v[96:99], v11 offset:40960
    ds_read_b128 v[100:103], v11 offset:43008
    ds_read_b128 v[104:107], v11 offset:45056
    ds_read_b128 v[108:111], v11 offset:47104
    s_waitcnt vmcnt(6) lgkmcnt(4)
    v_mfma_f32_16x16x32_bf16 v[48:51], v[80:83], a[80:83], v[48:51]
    v_mfma_f32_16x16x32_bf16 v[52:55], v[84:87], a[80:83], v[52:55]
    v_mfma_f32_16x16x32_bf16 v[56:59], v[88:91], a[80:83], v[56:59]
    v_mfma_f32_16x16x32_bf16 v[60:63], v[92:95], a[80:83], v[60:63]
    v_mfma_f32_16x16x32_bf16 v[64:67], v[80:83], a[84:87], v[64:67]
    v_mfma_f32_16x16x32_bf16 v[68:71], v[84:87], a[84:87], v[68:71]
    v_mfma_f32_16x16x32_bf16 v[72:75], v[88:91], a[84:87], v[72:75]
    v_mfma_f32_16x16x32_bf16 v[76:79], v[92:95], a[84:87], v[76:79]
    ds_read_b128 v[80:83], v10 offset:49152
    ds_read_b128 v[84:87], v10 offset:51200
    ds_read_b128 v[88:91], v10 offset:53248
    ds_read_b128 v[92:95], v10 offset:55296
    s_waitcnt vmcnt(4) lgkmcnt(4)
    v_mfma_f32_16x16x32_bf16 v[48:51], v[96:99], a[88:91], v[48:51]
    v_mfma_f32_16x16x32_bf16 v[52:55], v[100:103], a[88:91], v[52:55]
    v_mfma_f32_16x16x32_bf16 v[56:59], v[104:107], a[88:91], v[56:59]
    v_mfma_f32_16x16x32_bf16 v[60:63], v[108:111], a[88:91], v[60:63]
    v_mfma_f32_16x16x32_bf16 v[64:67], v[96:99], a[92:95], v[64:67]
    v_mfma_f32_16x16x32_bf16 v[68:71], v[100:103], a[92:95], v[68:71]
    v_mfma_f32_16x16x32_bf16 v[72:75], v[104:107], a[92:95], v[72:75]
    v_mfma_f32_16x16x32_bf16 v[76:79], v[108:111], a[92:95], v[76:79]
    ds_read_b128 v[96:99], v11 offset:49152
    ds_read_b128 v[100:103], v11 offset:51200
    ds_read_b128 v[104:107], v11 offset:53248
    ds_read_b128 v[108:111], v11 offset:55296
    s_waitcnt vmcnt(2) lgkmcnt(4)
    v_mfma_f32_16x16x32_bf16 v[48:51], v[80:83], a[96:99], v[48:51]
    v_mfma_f32_16x16x32_bf16 v[52:55], v[84:87], a[96:99], v[52:55]
    v_mfma_f32_16x16x32_bf16 v[56:59], v[88:91], a[96:99], v[56:59]
    v_mfma_f32_16x16x32_bf16 v[60:63], v[92:95], a[96:99], v[60:63]
    v_mfma_f32_16x16x32_bf16 v[64:67], v[80:83], a[100:103], v[64:67]
    v_mfma_f32_16x16x32_bf16 v[68:71], v[84:87], a[100:103], v[68:71]
    v_mfma_f32_16x16x32_bf16 v[72:75], v[88:91], a[100:103], v[72:75]
    v_mfma_f32_16x16x32_bf16 v[76:79], v[92:95], a[100:103], v[76:79]
    s_waitcnt vmcnt(0) lgkmcnt(0)
    v_mfma_f32_16x16x32_bf16 v[48:51], v[96:99], a[104:107], v[48:51]
    v_mfma_f32_16x16x32_bf16 v[52:55], v[100:103], a[104:107], v[52:55]
    v_mfma_f32_16x16x32_bf16 v[56:59], v[104:107], a[104:107], v[56:59]
    v_mfma_f32_16x16x32_bf16 v[60:63], v[108:111], a[104:107], v[60:63]
    v_mfma_f32_16x16x32_bf16 v[64:67], v[96:99], a[108:111], v[64:67]
    v_mfma_f32_16x16x32_bf16 v[68:71], v[100:103], a[108:111], v[68:71]
    v_mfma_f32_16x16x32_bf16 v[72:75], v[104:107], a[108:111], v[72:75]
    v_mfma_f32_16x16x32_bf16 v[76:79], v[108:111], a[108:111], v[76:79]
    s_lshl_b32 s39, s38, 5
    v_add_u32 v12, s39, v8
    v_lshlrev_b32 v12, 12, v12
    v_and_b32 v13, 1, v9
    v_lshl_add_u32 v12, v13, 5, v12
    v_lshrrev_b32 v13, 1, v9
    v_lshl_add_u32 v12, v13, 4, v12
    s_lshl_b32 s39, s34, 1
    v_add_u32 v12, s39, v12
    v_cmp_eq_u32 vcc, 12, v8
    v_mov_b32 v14, 0x3f803f80
    s_mov_b32 s39, 65536
    v_cvt_pk_bf16_f32 v16, v48, v49
    v_cvt_pk_bf16_f32 v17, v50, v51
    v_cvt_pk_bf16_f32 v18, v52, v53
    v_cvt_pk_bf16_f32 v19, v54, v55
    s_nop 1
    v_permlane16_swap_b32 v16, v18
    v_permlane16_swap_b32 v17, v19
    buffer_store_dwordx4 v[16:19], v12, s[20:23], 0 offen offset:0 sc1
    v_cvt_pk_bf16_f32 v20, v56, v57
    v_cvt_pk_bf16_f32 v21, v58, v59
    v_cvt_pk_bf16_f32 v22, v60, v61
    v_cvt_pk_bf16_f32 v23, v62, v63
    s_nop 1
    v_permlane16_swap_b32 v20, v22
    v_permlane16_swap_b32 v21, v23
    buffer_store_dwordx4 v[20:23], v12, s[20:23], 0 offen offset:64 sc1
    v_cvt_pk_bf16_f32 v24, v64, v65
    v_cvt_pk_bf16_f32 v25, v66, v67
    v_cvt_pk_bf16_f32 v26, v68, v69
    v_cvt_pk_bf16_f32 v27, v70, v71
    v_cndmask_b32 v24, v24, v14, vcc
    v_cndmask_b32 v25, v25, v14, vcc
    v_cndmask_b32 v26, v26, v14, vcc
    v_cndmask_b32 v27, v27, v14, vcc
    s_nop 1
    v_permlane16_swap_b32 v24, v26
    v_permlane16_swap_b32 v25, v27
    buffer_store_dwordx4 v[24:27], v12, s[20:23], s39 offen offset:0 sc1
    v_cvt_pk_bf16_f32 v28, v72, v73
    v_cvt_pk_bf16_f32 v29, v74, v75
    v_cvt_pk_bf16_f32 v30, v76, v77
    v_cvt_pk_bf16_f32 v31, v78, v79
    v_cndmask_b32 v28, v28, v14, vcc
    v_cndmask_b32 v29, v29, v14, vcc
    v_cndmask_b32 v30, v30, v14, vcc
    v_cndmask_b32 v31, v31, v14, vcc
    s_nop 1
    v_permlane16_swap_b32 v28, v30
    v_permlane16_swap_b32 v29, v31
    buffer_store_dwordx4 v[28:31], v12, s[20:23], s39 offen offset:64 sc1
L_k2_exit:
    s_endpgm
    .globl k3_kernel
    .p2align 8
    .type k3_kernel,@function
k3_kernel:
    s_load_dwordx2 s[4:5], s[0:1], 80
    s_cmp_ge_u32 s2, 256
    s_cbranch_scc1 L_k3_exit
    v_lshrrev_b32 v1, 6, v0
    s_nop 0
    v_readfirstlane_b32 s6, v1
    s_and_b32 s7, s2, 15
    s_lshr_b32 s31, s2, 4
    s_lshl_b32 s31, s31, 7
    s_lshl_b32 s32, s6, 4
    s_add_u32 s32, s32, s31
    v_and_b32 v1, 63, v0
    v_and_b32 v2, 15, v0
    v_bfe_u32 v3, v0, 4, 2
    v_lshrrev_b32 v4, 2, v1
    v_and_b32 v5, 3, v1
    v_lshrrev_b32 v6, 2, v4
    v_and_b32 v6, 2, v6
    v_xor_b32 v5, v5, v6
    v_lshlrev_b32 v4, 6, v4
    v_lshl_add_u32 v4, v5, 4, v4
    s_lshl_b32 s33, s7, 11
    s_add_u32 s33, s33, s31
    s_lshl_b32 s33, s33, 6
    v_add_u32 v4, s33, v4
    s_waitcnt lgkmcnt(0)
    s_add_u32 s8, s4, 8388608
    s_addc_u32 s9, s5, 0
    s_and_b32 s9, s9, 0xffff
    s_mov_b32 s10, 2097152
    s_mov_b32 s11, 0x00020000
    s_add_u32 s12, s4, 10469376
    s_addc_u32 s13, s5, 0
    s_and_b32 s13, s13, 0xffff
    s_mov_b32 s14, 2113536
    s_mov_b32 s15, 0x00020000
    s_add_u32 s16, s4, 12582400
    s_addc_u32 s17, s5, 0
    s_and_b32 s17, s17, 0xffff
    s_mov_b32 s18, 2097664
    s_mov_b32 s19, 0x00020000
    s_add_u32 s20, s4, 14680064
    s_addc_u32 s21, s5, 0
    s_and_b32 s21, s21, 0xffff
    s_mov_b32 s22, 2097152
    s_mov_b32 s23, 0x00020000
    s_lshl_b32 s34, s6, 12
    s_add_u32 s35, s34, 0
    s_mov_b32 m0, s35
    s_nop 0
    buffer_load_dwordx4 v4, s[12:15], s35 offen lds
    s_add_u32 s35, s34, 1024
    s_mov_b32 m0, s35
    s_nop 0
    buffer_load_dwordx4 v4, s[12:15], s35 offen lds
    s_add_u32 s35, s34, 2048
    s_mov_b32 m0, s35
    s_nop 0
    buffer_load_dwordx4 v4, s[12:15], s35 offen lds
    s_add_u32 s35, s34, 3072
    s_mov_b32 m0, s35
    s_nop 0
    buffer_load_dwordx4 v4, s[12:15], s35 offen lds
    s_lshl_b32 s35, s7, 11
    s_add_u32 s35, s35, s32
    s_lshl_b32 s35, s35, 6
    v_lshlrev_b32 v7, 6, v2
    v_lshl_add_u32 v7, v3, 4, v7
    buffer_load_dwordx4 v[8:11], v7, s[8:11], s35 offen
    s_lshl_b32 s36, s7, 5
    s_lshl_b32 s37, s6, 2
    s_add_u32 s36, s36, s37
    s_lshl_b32 s36, s36, 12
    s_lshl_b32 s38, s31, 1
    s_add_u32 s36, s36, s38
    s_and_b32 s37, s37, 15
    s_add_u32 s38, s37, 0
    v_xor_b32 v6, s38, v1
    v_lshlrev_b32 v6, 4, v6
    s_add_u32 s39, s36, 0
    s_add_u32 s35, s34, 32768
    s_mov_b32 m0, s35
    s_nop 0
    buffer_load_dwordx4 v6, s[16:19], s39 offen lds
    s_add_u32 s38, s37, 1
    v_xor_b32 v6, s38, v1
    v_lshlrev_b32 v6, 4, v6
    s_add_u32 s39, s36, 4096
    s_add_u32 s35, s34, 33792
    s_mov_b32 m0, s35
    s_nop 0
    buffer_load_dwordx4 v6, s[16:19], s39 offen lds
    s_add_u32 s38, s37, 2
    v_xor_b32 v6, s38, v1
    v_lshlrev_b32 v6, 4, v6
    s_add_u32 s39, s36, 8192
    s_add_u32 s35, s34, 34816
    s_mov_b32 m0, s35
    s_nop 0
    buffer_load_dwordx4 v6, s[16:19], s39 offen lds
    s_add_u32 s38, s37, 3
    v_xor_b32 v6, s38, v1
    v_lshlrev_b32 v6, 4, v6
    s_add_u32 s39, s36, 12288
    s_add_u32 s35, s34, 35840
    s_mov_b32 m0, s35
    s_nop 0
    buffer_load_dwordx4 v6, s[16:19], s39 offen lds
    s_mov_b32 s36, 0xf149f2ca
    v_mov_b32 v16, s36
    v_lshlrev_b32 v17, 3, v3
    v_add_u32 v24, 0, v17
    v_add_u32 v25, 1, v17
    v_add_u32 v26, 2, v17
    v_add_u32 v27, 3, v17
    v_add_u32 v28, 4, v17
    v_add_u32 v29, 5, v17
    v_add_u32 v30, 6, v17
    v_add_u32 v31, 7, v17
    s_sub_i32 s40, 256, s32
    s_sub_i32 s41, 224, s32
    s_sub_i32 s42, 192, s32
    s_sub_i32 s43, 160, s32
    s_sub_i32 s44, 128, s32
    s_sub_i32 s45, 96, s32
    s_sub_i32 s46, 64, s32
    s_sub_i32 s47, 32, s32
    v_add_u32 v18, 1, v2
    v_max_i32 v18, s40, v18
    v_cmp_ge_i32 vcc, v24, v18
    v_cmp_le_i32 s[50:51], v24, v2
    s_nop 0
    v_cndmask_b32_e64 v64, v16, 0, vcc
    v_cndmask_b32_e64 v128, v16, 0, s[50:51]
    v_cmp_ge_i32 vcc, v25, v18
    v_cmp_le_i32 s[50:51], v25, v2
    s_nop 0
    v_cndmask_b32_e64 v65, v16, 0, vcc
    v_cndmask_b32_e64 v129, v16, 0, s[50:51]
    v_cmp_ge_i32 vcc, v26, v18
    v_cmp_le_i32 s[50:51], v26, v2
    s_nop 0
    v_cndmask_b32_e64 v66, v16, 0, vcc
    v_cndmask_b32_e64 v130, v16, 0, s[50:51]
    v_cmp_ge_i32 vcc, v27, v18
    v_cmp_le_i32 s[50:51], v27, v2
    s_nop 0
    v_cndmask_b32_e64 v67, v16, 0, vcc
    v_cndmask_b32_e64 v131, v16, 0, s[50:51]
    v_cmp_ge_i32 vcc, v28, v18
    v_cmp_le_i32 s[50:51], v28, v2
    s_nop 0
    v_cndmask_b32_e64 v68, v16, 0, vcc
    v_cndmask_b32_e64 v132, v16, 0, s[50:51]
    v_cmp_ge_i32 vcc, v29, v18
    v_cmp_le_i32 s[50:51], v29, v2
    s_nop 0
    v_cndmask_b32_e64 v69, v16, 0, vcc
    v_cndmask_b32_e64 v133, v16, 0, s[50:51]
    v_cmp_ge_i32 vcc, v30, v18
    v_cmp_le_i32 s[50:51], v30, v2
    s_nop 0
    v_cndmask_b32_e64 v70, v16, 0, vcc
    v_cndmask_b32_e64 v134, v16, 0, s[50:51]
    v_cmp_ge_i32 vcc, v31, v18
    v_cmp_le_i32 s[50:51], v31, v2
    s_nop 0
    v_cndmask_b32_e64 v71, v16, 0, vcc
    v_cndmask_b32_e64 v135, v16, 0, s[50:51]
    v_cmp_le_i32_e64 vcc, s41, v24
    v_cmp_le_i32_e64 s[50:51], s41, v25
    v_cmp_le_i32_e64 s[52:53], s41, v26
    v_cmp_le_i32_e64 s[54:55], s41, v27
    v_cndmask_b32_e64 v72, v16, 0, vcc
    v_cndmask_b32_e64 v73, v16, 0, s[50:51]
    v_cndmask_b32_e64 v74, v16, 0, s[52:53]
    v_cndmask_b32_e64 v75, v16, 0, s[54:55]
    v_cmp_le_i32_e64 vcc, s41, v28
    v_cmp_le_i32_e64 s[50:51], s41, v29
    v_cmp_le_i32_e64 s[52:53], s41, v30
    v_cmp_le_i32_e64 s[54:55], s41, v31
    v_cndmask_b32_e64 v76, v16, 0, vcc
    v_cndmask_b32_e64 v77, v16, 0, s[50:51]
    v_cndmask_b32_e64 v78, v16, 0, s[52:53]
    v_cndmask_b32_e64 v79, v16, 0, s[54:55]
    v_cmp_le_i32_e64 vcc, s42, v24
    v_cmp_le_i32_e64 s[50:51], s42, v25
    v_cmp_le_i32_e64 s[52:53], s42, v26
    v_cmp_le_i32_e64 s[54:55], s42, v27
    v_cndmask_b32_e64 v80, v16, 0, vcc
    v_cndmask_b32_e64 v81, v16, 0, s[50:51]
    v_cndmask_b32_e64 v82, v16, 0, s[52:53]
    v_cndmask_b32_e64 v83, v16, 0, s[54:55]
    v_cmp_le_i32_e64 vcc, s42, v28
    v_cmp_le_i32_e64 s[50:51], s42, v29
    v_cmp_le_i32_e64 s[52:53], s42, v30
    v_cmp_le_i32_e64 s[54:55], s42, v31
    v_cndmask_b32_e64 v84, v16, 0, vcc
    v_cndmask_b32_e64 v85, v16, 0, s[50:51]
    v_cndmask_b32_e64 v86, v16, 0, s[52:53]
    v_cndmask_b32_e64 v87, v16, 0, s[54:55]
    v_cmp_le_i32_e64 vcc, s43, v24
    v_cmp_le_i32_e64 s[50:51], s43, v25
    v_cmp_le_i32_e64 s[52:53], s43, v26
    v_cmp_le_i32_e64 s[54:55], s43, v27
    v_cndmask_b32_e64 v88, v16, 0, vcc
    v_cndmask_b32_e64 v89, v16, 0, s[50:51]
    v_cndmask_b32_e64 v90, v16, 0, s[52:53]
    v_cndmask_b32_e64 v91, v16, 0, s[54:55]
    v_cmp_le_i32_e64 vcc, s43, v28
    v_cmp_le_i32_e64 s[50:51], s43, v29
    v_cmp_le_i32_e64 s[52:53], s43, v30
    v_cmp_le_i32_e64 s[54:55], s43, v31
    v_cndmask_b32_e64 v92, v16, 0, vcc
    v_cndmask_b32_e64 v93, v16, 0, s[50:51]
    v_cndmask_b32_e64 v94, v16, 0, s[52:53]
    v_cndmask_b32_e64 v95, v16, 0, s[54:55]
    v_cmp_le_i32_e64 vcc, s44, v24
    v_cmp_le_i32_e64 s[50:51], s44, v25
    v_cmp_le_i32_e64 s[52:53], s44, v26
    v_cmp_le_i32_e64 s[54:55], s44, v27
    v_cndmask_b32_e64 v96, v16, 0, vcc
    v_cndmask_b32_e64 v97, v16, 0, s[50:51]
    v_cndmask_b32_e64 v98, v16, 0, s[52:53]
    v_cndmask_b32_e64 v99, v16, 0, s[54:55]
    v_cmp_le_i32_e64 vcc, s44, v28
    v_cmp_le_i32_e64 s[50:51], s44, v29
    v_cmp_le_i32_e64 s[52:53], s44, v30
    v_cmp_le_i32_e64 s[54:55], s44, v31
    v_cndmask_b32_e64 v100, v16, 0, vcc
    v_cndmask_b32_e64 v101, v16, 0, s[50:51]
    v_cndmask_b32_e64 v102, v16, 0, s[52:53]
    v_cndmask_b32_e64 v103, v16, 0, s[54:55]
    v_cmp_le_i32_e64 vcc, s45, v24
    v_cmp_le_i32_e64 s[50:51], s45, v25
    v_cmp_le_i32_e64 s[52:53], s45, v26
    v_cmp_le_i32_e64 s[54:55], s45, v27
    v_cndmask_b32_e64 v104, v16, 0, vcc
    v_cndmask_b32_e64 v105, v16, 0, s[50:51]
    v_cndmask_b32_e64 v106, v16, 0, s[52:53]
    v_cndmask_b32_e64 v107, v16, 0, s[54:55]
    v_cmp_le_i32_e64 vcc, s45, v28
    v_cmp_le_i32_e64 s[50:51], s45, v29
    v_cmp_le_i32_e64 s[52:53], s45, v30
    v_cmp_le_i32_e64 s[54:55], s45, v31
    v_cndmask_b32_e64 v108, v16, 0, vcc
    v_cndmask_b32_e64 v109, v16, 0, s[50:51]
    v_cndmask_b32_e64 v110, v16, 0, s[52:53]
    v_cndmask_b32_e64 v111, v16, 0, s[54:55]
    v_cmp_le_i32_e64 vcc, s46, v24
    v_cmp_le_i32_e64 s[50:51], s46, v25
    v_cmp_le_i32_e64 s[52:53], s46, v26
    v_cmp_le_i32_e64 s[54:55], s46, v27
    v_cndmask_b32_e64 v112, v16, 0, vcc
    v_cndmask_b32_e64 v113, v16, 0, s[50:51]
    v_cndmask_b32_e64 v114, v16, 0, s[52:53]
    v_cndmask_b32_e64 v115, v16, 0, s[54:55]
    v_cmp_le_i32_e64 vcc, s46, v28
    v_cmp_le_i32_e64 s[50:51], s46, v29
    v_cmp_le_i32_e64 s[52:53], s46, v30
    v_cmp_le_i32_e64 s[54:55], s46, v31
    v_cndmask_b32_e64 v116, v16, 0, vcc
    v_cndmask_b32_e64 v117, v16, 0, s[50:51]
    v_cndmask_b32_e64 v118, v16, 0, s[52:53]
    v_cndmask_b32_e64 v119, v16, 0, s[54:55]
    v_cmp_le_i32_e64 vcc, s47, v24
    v_cmp_le_i32_e64 s[50:51], s47, v25
    v_cmp_le_i32_e64 s[52:53], s47, v26
    v_cmp_le_i32_e64 s[54:55], s47, v27
    v_cndmask_b32_e64 v120, v16, 0, vcc
    v_cndmask_b32_e64 v121, v16, 0, s[50:51]
    v_cndmask_b32_e64 v122, v16, 0, s[52:53]
    v_cndmask_b32_e64 v123, v16, 0, s[54:55]
    v_cmp_le_i32_e64 vcc, s47, v28
    v_cmp_le_i32_e64 s[50:51], s47, v29
    v_cmp_le_i32_e64 s[52:53], s47, v30
    v_cmp_le_i32_e64 s[54:55], s47, v31
    v_cndmask_b32_e64 v124, v16, 0, vcc
    v_cndmask_b32_e64 v125, v16, 0, s[50:51]
    v_cndmask_b32_e64 v126, v16, 0, s[52:53]
    v_cndmask_b32_e64 v127, v16, 0, s[54:55]
    v_lshrrev_b32 v19, 2, v2
    v_and_b32 v20, 3, v2
    v_lshlrev_b32 v21, 9, v19
    v_lshl_add_u32 v21, v20, 6, v21
    v_and_b32 v19, 1, v19
    v_lshlrev_b32 v19, 1, v19
    v_xor_b32 v19, v19, v3
    v_lshl_add_u32 v21, v19, 4, v21
    s_lshl_b32 s35, s6, 10
    v_add_u32 v21, s35, v21
    s_lshl_b32 s35, s6, 1
    v_add_u32 v22, s35, v3
    v_lshlrev_b32 v23, 10, v2
    v_add_u32 v19, 0, v22
    v_xor_b32 v19, v19, v2
    v_lshl_add_u32 v32, v19, 4, v23
    v_add_u32 v19, 4, v22
    v_xor_b32 v19, v19, v2
    v_lshl_add_u32 v33, v19, 4, v23
    v_add_u32 v19, 8, v22
    v_xor_b32 v19, v19, v2
    v_lshl_add_u32 v34, v19, 4, v23
    v_add_u32 v19, 12, v22
    v_xor_b32 v19, v19, v2
    v_lshl_add_u32 v35, v19, 4, v23
    v_add_u32 v19, 16, v22
    v_xor_b32 v19, v19, v2
    v_lshl_add_u32 v36, v19, 4, v23
    v_add_u32 v19, 20, v22
    v_xor_b32 v19, v19, v2
    v_lshl_add_u32 v37, v19, 4, v23
    v_add_u32 v19, 24, v22
    v_xor_b32 v19, v19, v2
    v_lshl_add_u32 v38, v19, 4, v23
    v_add_u32 v19, 28, v22
    v_xor_b32 v19, v19, v2
    v_lshl_add_u32 v39, v19, 4, v23
    v_add_u32 v19, 32, v22
    v_xor_b32 v19, v19, v2
    v_lshl_add_u32 v40, v19, 4, v23
    s_waitcnt vmcnt(0)
    s_barrier
    ds_read_b128 v[136:139], v21 offset:0
    ds_read_b128 v[140:143], v21 offset:256
    ds_read_b128 v[144:147], v21 offset:2048
    ds_read_b128 v[148:151], v21 offset:2304
    ds_read_b128 v[152:155], v21 offset:4096
    ds_read_b128 v[156:159], v21 offset:4352
    ds_read_b128 v[160:163], v21 offset:6144
    ds_read_b128 v[164:167], v21 offset:6400
    s_waitcnt lgkmcnt(7)
    v_mfma_f32_16x16x32_bf16 v[64:67], v[136:139], v[8:11], v[64:67]
    ds_read_b128 v[136:139], v21 offset:8192
    s_waitcnt lgkmcnt(7)
    v_mfma_f32_16x16x32_bf16 v[68:71], v[140:143], v[8:11], v[68:71]
    ds_read_b128 v[140:143], v21 offset:8448
    s_waitcnt lgkmcnt(7)
    v_mfma_f32_16x16x32_bf16 v[72:75], v[144:147], v[8:11], v[72:75]
    ds_read_b128 v[144:147], v21 offset:10240
    s_waitcnt lgkmcnt(7)
    v_mfma_f32_16x16x32_bf16 v[76:79], v[148:151], v[8:11], v[76:79]
    ds_read_b128 v[148:151], v21 offset:10496
    s_waitcnt lgkmcnt(7)
    v_mfma_f32_16x16x32_bf16 v[80:83], v[152:155], v[8:11], v[80:83]
    ds_read_b128 v[152:155], v21 offset:12288
    s_waitcnt lgkmcnt(7)
    v_mfma_f32_16x16x32_bf16 v[84:87], v[156:159], v[8:11], v[84:87]
    ds_read_b128 v[156:159], v21 offset:12544
    s_waitcnt lgkmcnt(7)
    v_mfma_f32_16x16x32_bf16 v[88:91], v[160:163], v[8:11], v[88:91]
    ds_read_b128 v[160:163], v21 offset:14336
    s_waitcnt lgkmcnt(7)
    v_mfma_f32_16x16x32_bf16 v[92:95], v[164:167], v[8:11], v[92:95]
    ds_read_b128 v[164:167], v21 offset:14592
    s_waitcnt lgkmcnt(7)
    v_mfma_f32_16x16x32_bf16 v[96:99], v[136:139], v[8:11], v[96:99]
    ds_read_b128 v[136:139], v21 offset:16384
    s_waitcnt lgkmcnt(7)
    v_mfma_f32_16x16x32_bf16 v[100:103], v[140:143], v[8:11], v[100:103]
    ds_read_b128 v[140:143], v21 offset:16640
    s_waitcnt lgkmcnt(7)
    v_mfma_f32_16x16x32_bf16 v[104:107], v[144:147], v[8:11], v[104:107]
    s_waitcnt lgkmcnt(6)
    v_mfma_f32_16x16x32_bf16 v[108:111], v[148:151], v[8:11], v[108:111]
    s_waitcnt lgkmcnt(5)
    v_mfma_f32_16x16x32_bf16 v[112:115], v[152:155], v[8:11], v[112:115]
    s_waitcnt lgkmcnt(4)
    v_mfma_f32_16x16x32_bf16 v[116:119], v[156:159], v[8:11], v[116:119]
    s_waitcnt lgkmcnt(3)
    v_mfma_f32_16x16x32_bf16 v[120:123], v[160:163], v[8:11], v[120:123]
    s_waitcnt lgkmcnt(2)
    v_mfma_f32_16x16x32_bf16 v[124:127], v[164:167], v[8:11], v[124:127]
    s_waitcnt lgkmcnt(1)
    v_mfma_f32_16x16x32_bf16 v[128:131], v[136:139], v[8:11], v[128:131]
    s_waitcnt lgkmcnt(0)
    v_mfma_f32_16x16x32_bf16 v[132:135], v[140:143], v[8:11], v[132:135]
    ds_read_b128 a[0:3], v32 offset:32768
    ds_read_b128 a[4:7], v32 offset:49152
    ds_read_b128 a[8:11], v33 offset:32768
    ds_read_b128 a[12:15], v33 offset:49152
    ds_read_b128 a[16:19], v34 offset:32768
    ds_read_b128 a[20:23], v34 offset:49152
    ds_read_b128 a[24:27], v35 offset:32768
    ds_read_b128 a[28:31], v35 offset:49152
    ds_read_b128 a[32:35], v36 offset:32768
    ds_read_b128 a[36:39], v36 offset:49152
    ds_read_b128 a[40:43], v37 offset:32768
    ds_read_b128 a[44:47], v37 offset:49152
    ds_read_b128 a[48:51], v38 offset:32768
    ds_read_b128 a[52:55], v38 offset:49152
    ds_read_b128 a[56:59], v39 offset:32768
    ds_read_b128 a[60:63], v39 offset:49152
    ds_read_b128 a[64:67], v40 offset:32768
    ds_read_b128 a[68:71], v40 offset:49152
    s_mov_b32 s37, 0x3e8b97f6
    v_max3_f32 v12, v64, v65, v66
    v_max3_f32 v13, v67, v68, v69
    v_max3_f32 v12, v12, v70, v71
    v_max3_f32 v13, v13, v72, v73
    v_max3_f32 v12, v12, v74, v75
    v_max3_f32 v13, v13, v76, v77
    v_max3_f32 v12, v12, v78, v79
    v_max3_f32 v13, v13, v80, v81
    v_max3_f32 v12, v12, v82, v83
    v_max3_f32 v13, v13, v84, v85
    v_max3_f32 v12, v12, v86, v87
    v_max3_f32 v13, v13, v88, v89
    v_max3_f32 v12, v12, v90, v91
    v_max3_f32 v13, v13, v92, v93
    v_max3_f32 v12, v12, v94, v95
    v_max3_f32 v13, v13, v96, v97
    v_max3_f32 v12, v12, v98, v99
    v_max3_f32 v13, v13, v100, v101
    v_max3_f32 v12, v12, v102, v103
    v_max3_f32 v13, v13, v104, v105
    v_max3_f32 v12, v12, v106, v107
    v_max3_f32 v13, v13, v108, v109
    v_max3_f32 v12, v12, v110, v111
    v_max3_f32 v13, v13, v112, v113
    v_max3_f32 v12, v12, v114, v115
    v_max3_f32 v13, v13, v116, v117
    v_max3_f32 v12, v12, v118, v119
    v_max3_f32 v13, v13, v120, v121
    v_max3_f32 v12, v12, v122, v123
    v_max3_f32 v13, v13, v124, v125
    v_max3_f32 v12, v12, v126, v127
    v_max3_f32 v13, v13, v128, v129
    v_max3_f32 v12, v12, v130, v131
    v_max3_f32 v13, v13, v132, v133
    v_max3_f32 v12, v12, v134, v135
    v_max_f32 v12, v12, v13
    v_mov_b32 v13, v12
    s_nop 1
    v_permlane32_swap_b32 v12, v13
    v_max_f32 v12, v12, v13
    v_mov_b32 v13, v12
    s_nop 1
    v_permlane16_swap_b32 v12, v13
    v_max_f32 v12, v12, v13
    v_mul_f32 v12, s37, v12
    s_waitcnt lgkmcnt(0)
    v_fma_f32 v64, v64, s37, -v12
    v_fma_f32 v65, v65, s37, -v12
    v_fma_f32 v66, v66, s37, -v12
    v_fma_f32 v67, v67, s37, -v12
    v_fma_f32 v68, v68, s37, -v12
    v_fma_f32 v69, v69, s37, -v12
    v_fma_f32 v70, v70, s37, -v12
    v_fma_f32 v71, v71, s37, -v12
    v_exp_f32 v64, v64
    v_exp_f32 v65, v65
    v_exp_f32 v66, v66
    v_exp_f32 v67, v67
    v_exp_f32 v68, v68
    v_exp_f32 v69, v69
    v_exp_f32 v70, v70
    v_exp_f32 v71, v71
    s_nop 0
    v_cvt_pk_bf16_f32 v64, v64, v65
    v_cvt_pk_bf16_f32 v65, v66, v67
    v_cvt_pk_bf16_f32 v66, v68, v69
    v_cvt_pk_bf16_f32 v67, v70, v71
    s_nop 1
    v_mfma_f32_16x16x32_bf16 v[168:171], a[0:3], v[64:67], 0
    v_mfma_f32_16x16x32_bf16 v[172:175], a[4:7], v[64:67], 0
    v_fma_f32 v72, v72, s37, -v12
    v_fma_f32 v73, v73, s37, -v12
    v_fma_f32 v74, v74, s37, -v12
    v_fma_f32 v75, v75, s37, -v12
    v_fma_f32 v76, v76, s37, -v12
    v_fma_f32 v77, v77, s37, -v12
    v_fma_f32 v78, v78, s37, -v12
    v_fma_f32 v79, v79, s37, -v12
    v_exp_f32 v72, v72
    v_exp_f32 v73, v73
    v_exp_f32 v74, v74
    v_exp_f32 v75, v75
    v_exp_f32 v76, v76
    v_exp_f32 v77, v77
    v_exp_f32 v78, v78
    v_exp_f32 v79, v79
    s_nop 0
    v_cvt_pk_bf16_f32 v72, v72, v73
    v_cvt_pk_bf16_f32 v73, v74, v75
    v_cvt_pk_bf16_f32 v74, v76, v77
    v_cvt_pk_bf16_f32 v75, v78, v79
    s_nop 1
    v_mfma_f32_16x16x32_bf16 v[168:171], a[8:11], v[72:75], v[168:171]
    v_mfma_f32_16x16x32_bf16 v[172:175], a[12:15], v[72:75], v[172:175]
    v_fma_f32 v80, v80, s37, -v12
    v_fma_f32 v81, v81, s37, -v12
    v_fma_f32 v82, v82, s37, -v12
    v_fma_f32 v83, v83, s37, -v12
    v_fma_f32 v84, v84, s37, -v12
    v_fma_f32 v85, v85, s37, -v12
    v_fma_f32 v86, v86, s37, -v12
    v_fma_f32 v87, v87, s37, -v12
    v_exp_f32 v80, v80
    v_exp_f32 v81, v81
    v_exp_f32 v82, v82
    v_exp_f32 v83, v83
    v_exp_f32 v84, v84
    v_exp_f32 v85, v85
    v_exp_f32 v86, v86
    v_exp_f32 v87, v87
    s_nop 0
    v_cvt_pk_bf16_f32 v80, v80, v81
    v_cvt_pk_bf16_f32 v81, v82, v83
    v_cvt_pk_bf16_f32 v82, v84, v85
    v_cvt_pk_bf16_f32 v83, v86, v87
    s_nop 1
    v_mfma_f32_16x16x32_bf16 v[168:171], a[16:19], v[80:83], v[168:171]
    v_mfma_f32_16x16x32_bf16 v[172:175], a[20:23], v[80:83], v[172:175]
    v_fma_f32 v88, v88, s37, -v12
    v_fma_f32 v89, v89, s37, -v12
    v_fma_f32 v90, v90, s37, -v12
    v_fma_f32 v91, v91, s37, -v12
    v_fma_f32 v92, v92, s37, -v12
    v_fma_f32 v93, v93, s37, -v12
    v_fma_f32 v94, v94, s37, -v12
    v_fma_f32 v95, v95, s37, -v12
    v_exp_f32 v88, v88
    v_exp_f32 v89, v89
    v_exp_f32 v90, v90
    v_exp_f32 v91, v91
    v_exp_f32 v92, v92
    v_exp_f32 v93, v93
    v_exp_f32 v94, v94
    v_exp_f32 v95, v95
    s_nop 0
    v_cvt_pk_bf16_f32 v88, v88, v89
    v_cvt_pk_bf16_f32 v89, v90, v91
    v_cvt_pk_bf16_f32 v90, v92, v93
    v_cvt_pk_bf16_f32 v91, v94, v95
    s_nop 1
    v_mfma_f32_16x16x32_bf16 v[168:171], a[24:27], v[88:91], v[168:171]
    v_mfma_f32_16x16x32_bf16 v[172:175], a[28:31], v[88:91], v[172:175]
    v_fma_f32 v96, v96, s37, -v12
    v_fma_f32 v97, v97, s37, -v12
    v_fma_f32 v98, v98, s37, -v12
    v_fma_f32 v99, v99, s37, -v12
    v_fma_f32 v100, v100, s37, -v12
    v_fma_f32 v101, v101, s37, -v12
    v_fma_f32 v102, v102, s37, -v12
    v_fma_f32 v103, v103, s37, -v12
    v_exp_f32 v96, v96
    v_exp_f32 v97, v97
    v_exp_f32 v98, v98
    v_exp_f32 v99, v99
    v_exp_f32 v100, v100
    v_exp_f32 v101, v101
    v_exp_f32 v102, v102
    v_exp_f32 v103, v103
    s_nop 0
    v_cvt_pk_bf16_f32 v96, v96, v97
    v_cvt_pk_bf16_f32 v97, v98, v99
    v_cvt_pk_bf16_f32 v98, v100, v101
    v_cvt_pk_bf16_f32 v99, v102, v103
    s_nop 1
    v_mfma_f32_16x16x32_bf16 v[168:171], a[32:35], v[96:99], v[168:171]
    v_mfma_f32_16x16x32_bf16 v[172:175], a[36:39], v[96:99], v[172:175]
    v_fma_f32 v104, v104, s37, -v12
    v_fma_f32 v105, v105, s37, -v12
    v_fma_f32 v106, v106, s37, -v12
    v_fma_f32 v107, v107, s37, -v12
    v_fma_f32 v108, v108, s37, -v12
    v_fma_f32 v109, v109, s37, -v12
    v_fma_f32 v110, v110, s37, -v12
    v_fma_f32 v111, v111, s37, -v12
    v_exp_f32 v104, v104
    v_exp_f32 v105, v105
    v_exp_f32 v106, v106
    v_exp_f32 v107, v107
    v_exp_f32 v108, v108
    v_exp_f32 v109, v109
    v_exp_f32 v110, v110
    v_exp_f32 v111, v111
    s_nop 0
    v_cvt_pk_bf16_f32 v104, v104, v105
    v_cvt_pk_bf16_f32 v105, v106, v107
    v_cvt_pk_bf16_f32 v106, v108, v109
    v_cvt_pk_bf16_f32 v107, v110, v111
    s_nop 1
    v_mfma_f32_16x16x32_bf16 v[168:171], a[40:43], v[104:107], v[168:171]
    v_mfma_f32_16x16x32_bf16 v[172:175], a[44:47], v[104:107], v[172:175]
    v_fma_f32 v112, v112, s37, -v12
    v_fma_f32 v113, v113, s37, -v12
    v_fma_f32 v114, v114, s37, -v12
    v_fma_f32 v115, v115, s37, -v12
    v_fma_f32 v116, v116, s37, -v12
    v_fma_f32 v117, v117, s37, -v12
    v_fma_f32 v118, v118, s37, -v12
    v_fma_f32 v119, v119, s37, -v12
    v_exp_f32 v112, v112
    v_exp_f32 v113, v113
    v_exp_f32 v114, v114
    v_exp_f32 v115, v115
    v_exp_f32 v116, v116
    v_exp_f32 v117, v117
    v_exp_f32 v118, v118
    v_exp_f32 v119, v119
    s_nop 0
    v_cvt_pk_bf16_f32 v112, v112, v113
    v_cvt_pk_bf16_f32 v113, v114, v115
    v_cvt_pk_bf16_f32 v114, v116, v117
    v_cvt_pk_bf16_f32 v115, v118, v119
    s_nop 1
    v_mfma_f32_16x16x32_bf16 v[168:171], a[48:51], v[112:115], v[168:171]
    v_mfma_f32_16x16x32_bf16 v[172:175], a[52:55], v[112:115], v[172:175]
    v_fma_f32 v120, v120, s37, -v12
    v_fma_f32 v121, v121, s37, -v12
    v_fma_f32 v122, v122, s37, -v12
    v_fma_f32 v123, v123, s37, -v12
    v_fma_f32 v124, v124, s37, -v12
    v_fma_f32 v125, v125, s37, -v12
    v_fma_f32 v126, v126, s37, -v12
    v_fma_f32 v127, v127, s37, -v12
    v_exp_f32 v120, v120
    v_exp_f32 v121, v121
    v_exp_f32 v122, v122
    v_exp_f32 v123, v123
    v_exp_f32 v124, v124
    v_exp_f32 v125, v125
    v_exp_f32 v126, v126
    v_exp_f32 v127, v127
    s_nop 0
    v_cvt_pk_bf16_f32 v120, v120, v121
    v_cvt_pk_bf16_f32 v121, v122, v123
    v_cvt_pk_bf16_f32 v122, v124, v125
    v_cvt_pk_bf16_f32 v123, v126, v127
    s_nop 1
    v_mfma_f32_16x16x32_bf16 v[168:171], a[56:59], v[120:123], v[168:171]
    v_mfma_f32_16x16x32_bf16 v[172:175], a[60:63], v[120:123], v[172:175]
    v_fma_f32 v128, v128, s37, -v12
    v_fma_f32 v129, v129, s37, -v12
    v_fma_f32 v130, v130, s37, -v12
    v_fma_f32 v131, v131, s37, -v12
    v_fma_f32 v132, v132, s37, -v12
    v_fma_f32 v133, v133, s37, -v12
    v_fma_f32 v134, v134, s37, -v12
    v_fma_f32 v135, v135, s37, -v12
    v_exp_f32 v128, v128
    v_exp_f32 v129, v129
    v_exp_f32 v130, v130
    v_exp_f32 v131, v131
    v_exp_f32 v132, v132
    v_exp_f32 v133, v133
    v_exp_f32 v134, v134
    v_exp_f32 v135, v135
    s_nop 0
    v_cvt_pk_bf16_f32 v128, v128, v129
    v_cvt_pk_bf16_f32 v129, v130, v131
    v_cvt_pk_bf16_f32 v130, v132, v133
    v_cvt_pk_bf16_f32 v131, v134, v135
    s_nop 1
    v_mfma_f32_16x16x32_bf16 v[168:171], a[64:67], v[128:131], v[168:171]
    v_mfma_f32_16x16x32_bf16 v[172:175], a[68:71], v[128:131], v[172:175]
    v_add_u32 v28, 48, v2
    v_lshlrev_b32 v28, 2, v28
    s_lshl_b32 s34, s7, 11
    s_add_u32 s34, s34, s32
    v_add_u32 v29, s34, v2
    v_lshlrev_b32 v29, 6, v29
    v_and_b32 v31, 1, v3
    v_lshl_add_u32 v29, v31, 5, v29
    v_lshrrev_b32 v31, 1, v3
    v_lshl_add_u32 v29, v31, 4, v29
    s_nop 4
    ds_bpermute_b32 v30, v28, v172
    s_waitcnt lgkmcnt(0)
    v_rcp_f32 v30, v30
    s_nop 0
    v_mul_f32 v168, v168, v30
    v_mul_f32 v169, v169, v30
    v_mul_f32 v170, v170, v30
    v_mul_f32 v171, v171, v30
    v_cvt_pk_bf16_f32 v16, v168, v169
    v_cvt_pk_bf16_f32 v17, v170, v171
    v_mul_f32 v172, v172, v30
    v_mul_f32 v173, v173, v30
    v_mul_f32 v174, v174, v30
    v_mul_f32 v175, v175, v30
    v_cvt_pk_bf16_f32 v18, v172, v173
    v_cvt_pk_bf16_f32 v19, v174, v175
    s_nop 1
    v_permlane16_swap_b32 v16, v18
    v_permlane16_swap_b32 v17, v19
    buffer_store_dwordx4 v[16:19], v29, s[20:23], 0 offen sc1
L_k3_exit:
    s_endpgm
    .globl k4_kernel
    .p2align 8
    .type k4_kernel,@function
k4_kernel:
    s_load_dwordx2 s[4:5], s[0:1], 80
    s_load_dwordx2 s[6:7], s[0:1], 0
    s_cmp_ge_u32 s2, 224
    s_cbranch_scc1 L_k4_kernel_exit
    v_lshrrev_b32 v1, 6, v0
    s_nop 0
    v_readfirstlane_b32 s33, v1
    s_and_b32 s34, s2, 31
    s_lshr_b32 s35, s2, 5
    s_lshl_b32 s34, s34, 6
    s_lshl_b32 s35, s35, 2
    s_and_b32 s44, s33, 1
    s_lshr_b32 s45, s33, 1
    s_lshl_b32 s36, s44, 1
    s_add_u32 s35, s35, s36
    v_and_b32 v2, 63, v0
    v_and_b32 v8, 15, v0
    v_bfe_u32 v9, v0, 4, 2
    v_lshrrev_b32 v3, 3, v2
    v_and_b32 v4, 7, v2
    v_xor_b32 v4, v4, v3
    s_lshl_b32 s36, s33, 3
    s_add_u32 s36, s36, s34
    v_add_u32 v5, s36, v3
    v_lshrrev_b32 v7, 2, v4
    v_lshl_add_u32 v5, v7, 11, v5
    v_lshlrev_b32 v5, 6, v5
    v_and_b32 v7, 3, v4
    v_lshl_add_u32 v16, v7, 4, v5
    s_waitcnt lgkmcnt(0)
    s_add_u32 s8, s4, 14680064
    s_addc_u32 s9, s5, 0
    s_and_b32 s9, s9, 0xffff
    s_mov_b32 s10, 2097152
    s_mov_b32 s11, 0x00020000
    s_add_u32 s12, s4, 3670016
    s_addc_u32 s13, s5, 0
    s_and_b32 s13, s13, 0xffff
    s_mov_b32 s14, 458752
    s_mov_b32 s15, 0x00020000
    s_mov_b32 s16, s4
    s_and_b32 s17, s5, 0xffff
    s_mov_b32 s18, 10752
    s_mov_b32 s19, 0x00020000
    s_mov_b32 s20, s6
    s_and_b32 s21, s7, 0xffff
    s_mov_b32 s22, 1835008
    s_mov_b32 s23, 0x00020000
    s_add_u32 s24, s4, 16777216
    s_addc_u32 s25, s5, 0
    s_and_b32 s25, s25, 0xffff
    s_mov_b32 s26, 1835008
    s_mov_b32 s27, 0x00020000
    v_lshlrev_b32 v6, 4, v2
    s_mul_i32 s40, s35, 16384
    s_lshl_b32 s37, s45, 10
    s_add_u32 s40, s40, s37
    s_add_u32 s47, s40, 16384
    s_lshl_b32 s41, s33, 10
    s_mov_b32 s38, 0
    s_add_u32 m0, s41, 0
    s_nop 0
    buffer_load_dwordx4 v16, s[8:11], s38 offen lds
    s_mov_b32 s38, 262144
    s_add_u32 m0, s41, 8192
    s_nop 0
    buffer_load_dwordx4 v16, s[8:11], s38 offen lds
    s_mov_b32 s38, 524288
    s_add_u32 m0, s41, 16384
    s_nop 0
    buffer_load_dwordx4 v16, s[8:11], s38 offen lds
    s_mov_b32 s38, 786432
    s_add_u32 m0, s41, 24576
    s_nop 0
    buffer_load_dwordx4 v16, s[8:11], s38 offen lds
    s_add_u32 s42, s40, 0
    s_add_u32 s43, s47, 0
    s_add_u32 s48, s40, 4096
    s_add_u32 s49, s47, 4096
    buffer_load_dwordx4 a[0:3], v6, s[12:15], s42 offen
    buffer_load_dwordx4 a[4:7], v6, s[12:15], s43 offen
    buffer_load_dwordx4 a[8:11], v6, s[12:15], s48 offen
    buffer_load_dwordx4 a[12:15], v6, s[12:15], s49 offen
    s_mov_b32 s38, 1048576
    s_add_u32 m0, s41, 32768
    s_nop 0
    buffer_load_dwordx4 v16, s[8:11], s38 offen lds
    s_mov_b32 s38, 1310720
    s_add_u32 m0, s41, 40960
    s_nop 0
    buffer_load_dwordx4 v16, s[8:11], s38 offen lds
    s_mov_b32 s38, 1572864
    s_add_u32 m0, s41, 49152
    s_nop 0
    buffer_load_dwordx4 v16, s[8:11], s38 offen lds
    s_mov_b32 s38, 1835008
    s_add_u32 m0, s41, 57344
    s_nop 0
    buffer_load_dwordx4 v16, s[8:11], s38 offen lds
    s_add_u32 s42, s40, 8192
    s_add_u32 s43, s47, 8192
    s_add_u32 s48, s40, 12288
    s_add_u32 s49, s47, 12288
    buffer_load_dwordx4 a[16:19], v6, s[12:15], s42 offen
    buffer_load_dwordx4 a[20:23], v6, s[12:15], s43 offen
    buffer_load_dwordx4 a[24:27], v6, s[12:15], s48 offen
    buffer_load_dwordx4 a[28:31], v6, s[12:15], s49 offen
    s_lshl_b32 s39, s45, 4
    s_add_u32 s39, s39, s34
    v_add_u32 v11, s39, v8
    v_mul_u32_u24 v11, 896, v11
    s_lshl_b32 s39, s35, 5
    v_add_u32 v11, s39, v11
    v_lshl_add_u32 v13, v9, 3, v11
    v_lshlrev_b32 v12, 4, v9
    s_lshl_b32 s39, s35, 6
    v_add_u32 v12, s39, v12
    s_mov_b32 s39, 3584
    buffer_load_dwordx4 v[20:23], v12, s[16:19], s39 offen
    buffer_load_dwordx4 v[24:27], v12, s[16:19], s39 offen offset:64
    buffer_load_dwordx2 v[28:29], v13, s[20:23], 0 offen
    buffer_load_dwordx2 v[30:31], v13, s[20:23], 0 offen offset:32
    v_and_b32 v13, 1, v9
    v_lshl_add_u32 v11, v13, 5, v11
    v_lshrrev_b32 v13, 1, v9
    v_lshl_add_u32 v11, v13, 4, v11
    s_and_b32 s39, s45, 1
    s_lshl_b32 s39, s39, 2
    v_add_u32 v13, s39, v9
    v_and_b32 v14, 7, v8
    v_xor_b32 v13, v13, v14
    v_lshlrev_b32 v15, 7, v8
    v_lshl_add_u32 v40, v13, 4, v15
    s_lshr_b32 s39, s45, 1
    s_lshl_b32 s39, s39, 13
    v_add_u32 v40, s39, v40
    v_add_u32 v41, 0x10000, v40
    v_add_u32 v42, 0x20000, v40
    s_waitcnt vmcnt(12)
    s_barrier
    ds_read_b128 v[80:83], v40 offset:0
    ds_read_b128 v[84:87], v40 offset:2048
    ds_read_b128 v[88:91], v40 offset:4096
    ds_read_b128 v[92:95], v40 offset:6144
    ds_read_b128 v[96:99], v40 offset:16384
    ds_read_b128 v[100:103], v40 offset:18432
    ds_read_b128 v[104:107], v40 offset:20480
    ds_read_b128 v[108:111], v40 offset:22528
    s_waitcnt lgkmcnt(4)
    v_mfma_f32_16x16x32_bf16 v[48:51], a[0:3], v[80:83], 0
    v_mfma_f32_16x16x32_bf16 v[52:55], a[0:3], v[84:87], 0
    v_mfma_f32_16x16x32_bf16 v[56:59], a[0:3], v[88:91], 0
    v_mfma_f32_16x16x32_bf16 v[60:63], a[0:3], v[92:95], 0
    v_mfma_f32_16x16x32_bf16 v[64:67], a[4:7], v[80:83], 0
    v_mfma_f32_16x16x32_bf16 v[68:71], a[4:7], v[84:87], 0
    v_mfma_f32_16x16x32_bf16 v[72:75], a[4:7], v[88:91], 0
    v_mfma_f32_16x16x32_bf16 v[76:79], a[4:7], v[92:95], 0
    s_waitcnt lgkmcnt(0)
    v_mfma_f32_16x16x32_bf16 v[48:51], a[8:11], v[96:99], v[48:51]
    v_mfma_f32_16x16x32_bf16 v[52:55], a[8:11], v[100:103], v[52:55]
    v_mfma_f32_16x16x32_bf16 v[56:59], a[8:11], v[104:107], v[56:59]
    v_mfma_f32_16x16x32_bf16 v[60:63], a[8:11], v[108:111], v[60:63]
    v_mfma_f32_16x16x32_bf16 v[64:67], a[12:15], v[96:99], v[64:67]
    v_mfma_f32_16x16x32_bf16 v[68:71], a[12:15], v[100:103], v[68:71]
    v_mfma_f32_16x16x32_bf16 v[72:75], a[12:15], v[104:107], v[72:75]
    v_mfma_f32_16x16x32_bf16 v[76:79], a[12:15], v[108:111], v[76:79]
    s_waitcnt vmcnt(4)
    s_barrier
    ds_read_b128 v[80:83], v40 offset:32768
    ds_read_b128 v[84:87], v40 offset:34816
    ds_read_b128 v[88:91], v40 offset:36864
    ds_read_b128 v[92:95], v40 offset:38912
    ds_read_b128 v[96:99], v40 offset:49152
    ds_read_b128 v[100:103], v40 offset:51200
    ds_read_b128 v[104:107], v40 offset:53248
    ds_read_b128 v[108:111], v40 offset:55296
    s_waitcnt lgkmcnt(4)
    v_mfma_f32_16x16x32_bf16 v[48:51], a[16:19], v[80:83], v[48:51]
    v_mfma_f32_16x16x32_bf16 v[52:55], a[16:19], v[84:87], v[52:55]
    v_mfma_f32_16x16x32_bf16 v[56:59], a[16:19], v[88:91], v[56:59]
    v_mfma_f32_16x16x32_bf16 v[60:63], a[16:19], v[92:95], v[60:63]
    v_mfma_f32_16x16x32_bf16 v[64:67], a[20:23], v[80:83], v[64:67]
    v_mfma_f32_16x16x32_bf16 v[68:71], a[20:23], v[84:87], v[68:71]
    v_mfma_f32_16x16x32_bf16 v[72:75], a[20:23], v[88:91], v[72:75]
    v_mfma_f32_16x16x32_bf16 v[76:79], a[20:23], v[92:95], v[76:79]
    s_waitcnt lgkmcnt(0)
    v_mfma_f32_16x16x32_bf16 v[48:51], a[24:27], v[96:99], v[48:51]
    v_mfma_f32_16x16x32_bf16 v[52:55], a[24:27], v[100:103], v[52:55]
    v_mfma_f32_16x16x32_bf16 v[56:59], a[24:27], v[104:107], v[56:59]
    v_mfma_f32_16x16x32_bf16 v[60:63], a[24:27], v[108:111], v[60:63]
    v_mfma_f32_16x16x32_bf16 v[64:67], a[28:31], v[96:99], v[64:67]
    v_mfma_f32_16x16x32_bf16 v[68:71], a[28:31], v[100:103], v[68:71]
    v_mfma_f32_16x16x32_bf16 v[72:75], a[28:31], v[104:107], v[72:75]
    v_mfma_f32_16x16x32_bf16 v[76:79], a[28:31], v[108:111], v[76:79]
    s_lshl_b32 s39, s44, 13
    s_lshl_b32 s38, s45, 11
    s_add_u32 s39, s39, s38
    s_add_u32 s39, s39, 65536
    v_add_u32 v13, s39, v6
    s_lshl_b32 s39, s45, 14
    s_lshl_b32 s38, s44, 13
    s_add_u32 s39, s39, s38
    s_add_u32 s39, s39, 65536
    v_add_u32 v14, s39, v6
    ds_write_b128 v13, v[48:51] offset:0
    ds_write_b128 v13, v[64:67] offset:1024
    ds_write_b128 v13, v[52:55] offset:16384
    ds_write_b128 v13, v[68:71] offset:17408
    ds_write_b128 v13, v[56:59] offset:32768
    ds_write_b128 v13, v[72:75] offset:33792
    ds_write_b128 v13, v[60:63] offset:49152
    ds_write_b128 v13, v[76:79] offset:50176
    s_waitcnt lgkmcnt(0)
    s_barrier
    ds_read_b128 v[80:83], v14 offset:0
    ds_read_b128 v[84:87], v14 offset:1024
    ds_read_b128 v[88:91], v14 offset:2048
    ds_read_b128 v[92:95], v14 offset:3072
    ds_read_b128 v[96:99], v14 offset:4096
    ds_read_b128 v[100:103], v14 offset:5120
    ds_read_b128 v[104:107], v14 offset:6144
    ds_read_b128 v[108:111], v14 offset:7168
    s_waitcnt vmcnt(0) lgkmcnt(0)
    v_pk_add_f32 v[80:81], v[80:81], v[88:89]
    v_pk_add_f32 v[96:97], v[96:97], v[104:105]
    v_pk_add_f32 v[80:81], v[80:81], v[96:97]
    v_pk_add_f32 v[82:83], v[82:83], v[90:91]
    v_pk_add_f32 v[98:99], v[98:99], v[106:107]
    v_pk_add_f32 v[82:83], v[82:83], v[98:99]
    v_pk_add_f32 v[84:85], v[84:85], v[92:93]
    v_pk_add_f32 v[100:101], v[100:101], v[108:109]
    v_pk_add_f32 v[84:85], v[84:85], v[100:101]
    v_pk_add_f32 v[86:87], v[86:87], v[94:95]
    v_pk_add_f32 v[102:103], v[102:103], v[110:111]
    v_pk_add_f32 v[86:87], v[86:87], v[102:103]
    v_lshlrev_b32 v36, 16, v28
    v_and_b32 v37, 0xffff0000, v28
    v_lshlrev_b32 v38, 16, v29
    v_and_b32 v39, 0xffff0000, v29
    v_fmac_f32 v36, v20, v80
    v_fmac_f32 v37, v21, v81
    v_fmac_f32 v38, v22, v82
    v_fmac_f32 v39, v23, v83
    v_cvt_pk_bf16_f32 v28, v36, v37
    v_cvt_pk_bf16_f32 v29, v38, v39
    v_lshlrev_b32 v36, 16, v30
    v_and_b32 v37, 0xffff0000, v30
    v_lshlrev_b32 v38, 16, v31
    v_and_b32 v39, 0xffff0000, v31
    v_fmac_f32 v36, v24, v84
    v_fmac_f32 v37, v25, v85
    v_fmac_f32 v38, v26, v86
    v_fmac_f32 v39, v27, v87
    v_cvt_pk_bf16_f32 v30, v36, v37
    v_cvt_pk_bf16_f32 v31, v38, v39
    s_nop 1
    v_permlane16_swap_b32 v28, v30
    v_permlane16_swap_b32 v29, v31
    buffer_store_dwordx4 v[28:31], v11, s[24:27], 0 offen sc1
L_k4_kernel_exit:
    s_endpgm
    .globl k5_kernel
    .p2align 8
    .type k5_kernel,@function
k5_kernel:
    s_load_dwordx2 s[4:5], s[0:1], 80
    s_cmp_ge_u32 s2, 256
    s_cbranch_scc1 L_k5_exit
    v_lshrrev_b32 v1, 6, v0
    s_nop 0
    v_readfirstlane_b32 s33, v1
    s_bfe_u32 s34, s2, 0x20001
    s_lshl_b32 s34, s34, 3
    s_bfe_u32 s36, s2, 0x30003
    s_add_u32 s34, s34, s36
    s_lshl_b32 s34, s34, 6
    s_and_b32 s35, s2, 1
    s_lshl_b32 s35, s35, 2
    s_lshr_b32 s36, s2, 6
    s_add_u32 s35, s35, s36
    s_mul_i32 s35, s35, 14
    s_lshl_b32 s36, s33, 1
    s_add_u32 s35, s35, s36
    v_lshrrev_b32 v2, 3, v0
    v_and_b32 v3, 7, v0
    v_add_u32 v4, s34, v2
    v_mul_u32_u24 v4, 896, v4
    v_lshl_add_u32 v4, v3, 4, v4
    v_lshlrev_b32 v5, 4, v0
    v_and_b32 v6, 63, v0
    v_lshlrev_b32 v6, 4, v6
    s_waitcnt lgkmcnt(0)
    s_add_u32 s8, s4, 16777216
    s_addc_u32 s9, s5, 0
    s_and_b32 s9, s9, 0xffff
    s_mov_b32 s10, 1835008
    s_mov_b32 s11, 0x00020000
    s_add_u32 s12, s4, 4194304
    s_addc_u32 s13, s5, 0
    s_and_b32 s13, s13, 0xffff
    s_mov_b32 s14, 1605632
    s_mov_b32 s15, 0x00020000
    s_add_u32 s16, s4, 5376
    s_addc_u32 s17, s5, 0
    s_and_b32 s17, s17, 0xffff
    s_mov_b32 s18, 3584
    s_mov_b32 s19, 0x00020000
    s_add_u32 s24, s4, 18874368
    s_addc_u32 s25, s5, 0
    s_and_b32 s25, s25, 0xffff
    s_mov_b32 s26, 7340032
    s_mov_b32 s27, 0x00020000
    buffer_load_dwordx4 v[8:11], v5, s[16:19], 0 offen
    buffer_load_dwordx4 v[16:19], v4, s[8:11], 0 offen offset:0
    buffer_load_dwordx4 v[20:23], v4, s[8:11], 0 offen offset:128
    buffer_load_dwordx4 v[24:27], v4, s[8:11], 0 offen offset:256
    buffer_load_dwordx4 v[28:31], v4, s[8:11], 0 offen offset:384
    buffer_load_dwordx4 v[32:35], v4, s[8:11], 0 offen offset:512
    buffer_load_dwordx4 v[36:39], v4, s[8:11], 0 offen offset:640
    buffer_load_dwordx4 v[40:43], v4, s[8:11], 0 offen offset:768
    s_add_u32 s44, s35, 0
    s_mul_i32 s44, s44, 14336
    s_add_u32 s45, s44, 4096
    s_add_u32 s46, s44, 8192
    s_add_u32 s47, s44, 12288
    s_add_u32 s48, s35, 1
    s_mul_i32 s48, s48, 14336
    s_add_u32 s49, s48, 4096
    s_add_u32 s50, s48, 8192
    s_add_u32 s51, s48, 12288
    s_cmp_eq_u32 s33, 7
    s_cselect_b64 s[60:61], 0, -1
    s_mov_b64 exec, s[60:61]
    buffer_load_dwordx4 a[0:3], v6, s[12:15], s44 offen offset:0
    s_mov_b64 exec, -1
    s_mov_b64 exec, s[60:61]
    buffer_load_dwordx4 a[4:7], v6, s[12:15], s48 offen offset:0
    s_mov_b64 exec, -1
    s_mov_b64 exec, s[60:61]
    buffer_load_dwordx4 a[8:11], v6, s[12:15], s44 offen offset:1024
    s_mov_b64 exec, -1
    s_mov_b64 exec, s[60:61]
    buffer_load_dwordx4 a[12:15], v6, s[12:15], s48 offen offset:1024
    s_mov_b64 exec, -1
    v_and_b32 v7, 7, v2
    v_xor_b32 v7, v7, v3
    v_lshlrev_b32 v7, 4, v7
    v_lshl_add_u32 v7, v2, 7, v7
    s_waitcnt vmcnt(11)
    v_cmp_le_u32 vcc, 112, v0
    v_add_f32 v12, 1.0, v8
    v_add_f32 v13, 1.0, v9
    v_add_f32 v14, 1.0, v10
    v_add_f32 v15, 1.0, v11
    v_cvt_pk_bf16_f32 v44, v12, v13
    v_cvt_pk_bf16_f32 v45, v14, v15
    v_lshlrev_b32 v12, 16, v44
    v_and_b32 v13, 0xffff0000, v44
    v_lshlrev_b32 v14, 16, v45
    v_and_b32 v15, 0xffff0000, v45
    v_cndmask_b32 v8, v8, v12, vcc
    v_cndmask_b32 v9, v9, v13, vcc
    v_cndmask_b32 v10, v10, v14, vcc
    v_cndmask_b32 v11, v11, v15, vcc
    v_cmp_gt_u32 vcc, 224, v0
    s_and_saveexec_b64 s[36:37], vcc
    ds_write_b128 v5, v[8:11] offset:57344
    s_mov_b64 exec, s[36:37]
    s_waitcnt vmcnt(4)
    v_lshlrev_b32 v44, 16, v16
    v_and_b32 v45, 0xffff0000, v16
    v_lshlrev_b32 v46, 16, v17
    v_and_b32 v47, 0xffff0000, v17
    v_lshlrev_b32 v48, 16, v18
    v_and_b32 v49, 0xffff0000, v18
    v_lshlrev_b32 v50, 16, v19
    v_and_b32 v51, 0xffff0000, v19
    v_lshlrev_b32 v52, 16, v20
    v_and_b32 v53, 0xffff0000, v20
    v_lshlrev_b32 v54, 16, v21
    v_and_b32 v55, 0xffff0000, v21
    v_lshlrev_b32 v56, 16, v22
    v_and_b32 v57, 0xffff0000, v22
    v_lshlrev_b32 v58, 16, v23
    v_and_b32 v59, 0xffff0000, v23
    s_mov_b64 exec, s[60:61]
    buffer_load_dwordx4 a[16:19], v6, s[12:15], s44 offen offset:2048
    s_mov_b64 exec, -1
    v_lshlrev_b32 v60, 16, v24
    v_and_b32 v61, 0xffff0000, v24
    v_lshlrev_b32 v62, 16, v25
    v_and_b32 v63, 0xffff0000, v25
    v_lshlrev_b32 v64, 16, v26
    v_and_b32 v65, 0xffff0000, v26
    v_lshlrev_b32 v66, 16, v27
    v_and_b32 v67, 0xffff0000, v27
    v_lshlrev_b32 v68, 16, v28
    v_and_b32 v69, 0xffff0000, v28
    v_lshlrev_b32 v70, 16, v29
    v_and_b32 v71, 0xffff0000, v29
    v_lshlrev_b32 v72, 16, v30
    v_and_b32 v73, 0xffff0000, v30
    v_lshlrev_b32 v74, 16, v31
    v_and_b32 v75, 0xffff0000, v31
    s_mov_b64 exec, s[60:61]
    buffer_load_dwordx4 a[20:23], v6, s[12:15], s48 offen offset:2048
    s_mov_b64 exec, -1
    v_lshlrev_b32 v76, 16, v32
    v_and_b32 v77, 0xffff0000, v32
    v_lshlrev_b32 v78, 16, v33
    v_and_b32 v79, 0xffff0000, v33
    v_lshlrev_b32 v80, 16, v34
    v_and_b32 v81, 0xffff0000, v34
    v_lshlrev_b32 v82, 16, v35
    v_and_b32 v83, 0xffff0000, v35
    v_lshlrev_b32 v84, 16, v36
    v_and_b32 v85, 0xffff0000, v36
    v_lshlrev_b32 v86, 16, v37
    v_and_b32 v87, 0xffff0000, v37
    v_lshlrev_b32 v88, 16, v38
    v_and_b32 v89, 0xffff0000, v38
    v_lshlrev_b32 v90, 16, v39
    v_and_b32 v91, 0xffff0000, v39
    s_mov_b64 exec, s[60:61]
    buffer_load_dwordx4 a[24:27], v6, s[12:15], s44 offen offset:3072
    s_mov_b64 exec, -1
    v_lshlrev_b32 v92, 16, v40
    v_and_b32 v93, 0xffff0000, v40
    v_lshlrev_b32 v94, 16, v41
    v_and_b32 v95, 0xffff0000, v41
    v_lshlrev_b32 v96, 16, v42
    v_and_b32 v97, 0xffff0000, v42
    v_lshlrev_b32 v98, 16, v43
    v_and_b32 v99, 0xffff0000, v43
    v_pk_add_f32 v[100:101], v[44:45], v[46:47]
    v_pk_add_f32 v[102:103], v[48:49], v[50:51]
    v_pk_add_f32 v[104:105], v[52:53], v[54:55]
    v_pk_add_f32 v[106:107], v[56:57], v[58:59]
    v_pk_add_f32 v[100:101], v[100:101], v[60:61]
    v_pk_add_f32 v[102:103], v[102:103], v[62:63]
    v_pk_add_f32 v[104:105], v[104:105], v[64:65]
    v_pk_add_f32 v[106:107], v[106:107], v[66:67]
    s_mov_b64 exec, s[60:61]
    buffer_load_dwordx4 a[28:31], v6, s[12:15], s48 offen offset:3072
    s_mov_b64 exec, -1
    v_pk_add_f32 v[100:101], v[100:101], v[68:69]
    v_pk_add_f32 v[102:103], v[102:103], v[70:71]
    v_pk_add_f32 v[104:105], v[104:105], v[72:73]
    v_pk_add_f32 v[106:107], v[106:107], v[74:75]
    v_pk_add_f32 v[100:101], v[100:101], v[76:77]
    v_pk_add_f32 v[102:103], v[102:103], v[78:79]
    v_pk_add_f32 v[104:105], v[104:105], v[80:81]
    v_pk_add_f32 v[106:107], v[106:107], v[82:83]
    v_pk_add_f32 v[100:101], v[100:101], v[84:85]
    v_pk_add_f32 v[102:103], v[102:103], v[86:87]
    v_pk_add_f32 v[104:105], v[104:105], v[88:89]
    v_pk_add_f32 v[106:107], v[106:107], v[90:91]
    v_pk_add_f32 v[100:101], v[100:101], v[92:93]
    v_pk_add_f32 v[102:103], v[102:103], v[94:95]
    v_pk_add_f32 v[104:105], v[104:105], v[96:97]
    v_pk_add_f32 v[106:107], v[106:107], v[98:99]
    s_mov_b64 exec, s[60:61]
    buffer_load_dwordx4 a[32:35], v6, s[12:15], s45 offen offset:0
    s_mov_b64 exec, -1
    v_pk_add_f32 v[100:101], v[100:101], v[102:103]
    v_pk_add_f32 v[104:105], v[104:105], v[106:107]
    v_pk_add_f32 v[100:101], v[100:101], v[104:105]
    v_add_f32 v100, v100, v101
    s_nop 1
    v_add_f32_dpp v100, v100, v100 quad_perm:[1,0,3,2] row_mask:0xf bank_mask:0xf
    s_nop 1
    v_add_f32_dpp v100, v100, v100 quad_perm:[2,3,0,1] row_mask:0xf bank_mask:0xf
    s_nop 1
    v_add_f32_dpp v100, v100, v100 row_half_mirror row_mask:0xf bank_mask:0xf
    v_mul_f32 v100, -0.002232142857142857, v100
    v_mov_b32 v101, v100
    v_pk_add_f32 v[44:45], v[44:45], v[100:101]
    v_pk_add_f32 v[46:47], v[46:47], v[100:101]
    v_pk_add_f32 v[48:49], v[48:49], v[100:101]
    v_pk_add_f32 v[50:51], v[50:51], v[100:101]
    s_mov_b64 exec, s[60:61]
    buffer_load_dwordx4 a[36:39], v6, s[12:15], s49 offen offset:0
    s_mov_b64 exec, -1
    v_pk_add_f32 v[52:53], v[52:53], v[100:101]
    v_pk_add_f32 v[54:55], v[54:55], v[100:101]
    v_pk_add_f32 v[56:57], v[56:57], v[100:101]
    v_pk_add_f32 v[58:59], v[58:59], v[100:101]
    v_pk_add_f32 v[60:61], v[60:61], v[100:101]
    v_pk_add_f32 v[62:63], v[62:63], v[100:101]
    v_pk_add_f32 v[64:65], v[64:65], v[100:101]
    v_pk_add_f32 v[66:67], v[66:67], v[100:101]
    v_pk_add_f32 v[68:69], v[68:69], v[100:101]
    v_pk_add_f32 v[70:71], v[70:71], v[100:101]
    v_pk_add_f32 v[72:73], v[72:73], v[100:101]
    v_pk_add_f32 v[74:75], v[74:75], v[100:101]
    v_pk_add_f32 v[76:77], v[76:77], v[100:101]
    v_pk_add_f32 v[78:79], v[78:79], v[100:101]
    v_pk_add_f32 v[80:81], v[80:81], v[100:101]
    v_pk_add_f32 v[82:83], v[82:83], v[100:101]
    s_mov_b64 exec, s[60:61]
    buffer_load_dwordx4 a[40:43], v6, s[12:15], s45 offen offset:1024
    s_mov_b64 exec, -1
    v_pk_add_f32 v[84:85], v[84:85], v[100:101]
    v_pk_add_f32 v[86:87], v[86:87], v[100:101]
    v_pk_add_f32 v[88:89], v[88:89], v[100:101]
    v_pk_add_f32 v[90:91], v[90:91], v[100:101]
    v_pk_add_f32 v[92:93], v[92:93], v[100:101]
    v_pk_add_f32 v[94:95], v[94:95], v[100:101]
    v_pk_add_f32 v[96:97], v[96:97], v[100:101]
    v_pk_add_f32 v[98:99], v[98:99], v[100:101]
    v_pk_mul_f32 v[102:103], v[44:45], v[44:45]
    v_pk_mul_f32 v[104:105], v[46:47], v[46:47]
    v_pk_mul_f32 v[106:107], v[48:49], v[48:49]
    v_pk_mul_f32 v[108:109], v[50:51], v[50:51]
    v_pk_fma_f32 v[102:103], v[52:53], v[52:53], v[102:103]
    v_pk_fma_f32 v[104:105], v[54:55], v[54:55], v[104:105]
    v_pk_fma_f32 v[106:107], v[56:57], v[56:57], v[106:107]
    v_pk_fma_f32 v[108:109], v[58:59], v[58:59], v[108:109]
    s_mov_b64 exec, s[60:61]
    buffer_load_dwordx4 a[44:47], v6, s[12:15], s49 offen offset:1024
    s_mov_b64 exec, -1
    v_pk_fma_f32 v[102:103], v[60:61], v[60:61], v[102:103]
    v_pk_fma_f32 v[104:105], v[62:63], v[62:63], v[104:105]
    v_pk_fma_f32 v[106:107], v[64:65], v[64:65], v[106:107]
    v_pk_fma_f32 v[108:109], v[66:67], v[66:67], v[108:109]
    v_pk_fma_f32 v[102:103], v[68:69], v[68:69], v[102:103]
    v_pk_fma_f32 v[104:105], v[70:71], v[70:71], v[104:105]
    v_pk_fma_f32 v[106:107], v[72:73], v[72:73], v[106:107]
    v_pk_fma_f32 v[108:109], v[74:75], v[74:75], v[108:109]
    v_pk_fma_f32 v[102:103], v[76:77], v[76:77], v[102:103]
    v_pk_fma_f32 v[104:105], v[78:79], v[78:79], v[104:105]
    v_pk_fma_f32 v[106:107], v[80:81], v[80:81], v[106:107]
    v_pk_fma_f32 v[108:109], v[82:83], v[82:83], v[108:109]
    v_pk_fma_f32 v[102:103], v[84:85], v[84:85], v[102:103]
    v_pk_fma_f32 v[104:105], v[86:87], v[86:87], v[104:105]
    v_pk_fma_f32 v[106:107], v[88:89], v[88:89], v[106:107]
    v_pk_fma_f32 v[108:109], v[90:91], v[90:91], v[108:109]
    s_mov_b64 exec, s[60:61]
    buffer_load_dwordx4 a[48:51], v6, s[12:15], s45 offen offset:2048
    s_mov_b64 exec, -1
    v_pk_fma_f32 v[102:103], v[92:93], v[92:93], v[102:103]
    v_pk_fma_f32 v[104:105], v[94:95], v[94:95], v[104:105]
    v_pk_fma_f32 v[106:107], v[96:97], v[96:97], v[106:107]
    v_pk_fma_f32 v[108:109], v[98:99], v[98:99], v[108:109]
    v_pk_add_f32 v[102:103], v[102:103], v[104:105]
    v_pk_add_f32 v[106:107], v[106:107], v[108:109]
    v_pk_add_f32 v[102:103], v[102:103], v[106:107]
    v_add_f32 v102, v102, v103
    s_nop 1
    v_add_f32_dpp v102, v102, v102 quad_perm:[1,0,3,2] row_mask:0xf bank_mask:0xf
    s_nop 1
    v_add_f32_dpp v102, v102, v102 quad_perm:[2,3,0,1] row_mask:0xf bank_mask:0xf
    s_nop 1
    v_add_f32_dpp v102, v102, v102 row_half_mirror row_mask:0xf bank_mask:0xf
    v_mov_b32 v104, 0x3727c5ac
    v_fmac_f32 v104, 0.002232142857142857, v102
    s_mov_b64 exec, s[60:61]
    buffer_load_dwordx4 a[52:55], v6, s[12:15], s49 offen offset:2048
    s_mov_b64 exec, -1
    v_rsq_f32 v104, v104
    v_lshlrev_b32 v106, 5, v3
    s_waitcnt lgkmcnt(0)
    s_barrier
    v_mov_b32 v105, v104
    ds_read_b128 v[108:111], v106 offset:59136
    ds_read_b128 v[112:115], v106 offset:59152
    ds_read_b128 v[116:119], v106 offset:57344
    ds_read_b128 v[120:123], v106 offset:57360
    v_pk_mul_f32 v[44:45], v[44:45], v[104:105]
    v_pk_mul_f32 v[46:47], v[46:47], v[104:105]
    v_pk_mul_f32 v[48:49], v[48:49], v[104:105]
    v_pk_mul_f32 v[50:51], v[50:51], v[104:105]
    s_waitcnt lgkmcnt(0)
    v_pk_fma_f32 v[44:45], v[44:45], v[108:109], v[116:117]
    v_pk_fma_f32 v[46:47], v[46:47], v[110:111], v[118:119]
    s_mov_b64 exec, s[60:61]
    buffer_load_dwordx4 a[56:59], v6, s[12:15], s45 offen offset:3072
    s_mov_b64 exec, -1
    v_pk_fma_f32 v[48:49], v[48:49], v[112:113], v[120:121]
    v_pk_fma_f32 v[50:51], v[50:51], v[114:115], v[122:123]
    v_cvt_pk_bf16_f32 v16, v44, v45
    v_cvt_pk_bf16_f32 v17, v46, v47
    v_cvt_pk_bf16_f32 v18, v48, v49
    v_cvt_pk_bf16_f32 v19, v50, v51
    ds_write_b128 v7, v[16:19] offset:0
    ds_read_b128 v[108:111], v106 offset:59392
    ds_read_b128 v[112:115], v106 offset:59408
    ds_read_b128 v[116:119], v106 offset:57600
    ds_read_b128 v[120:123], v106 offset:57616
    v_pk_mul_f32 v[52:53], v[52:53], v[104:105]
    v_pk_mul_f32 v[54:55], v[54:55], v[104:105]
    v_pk_mul_f32 v[56:57], v[56:57], v[104:105]
    v_pk_mul_f32 v[58:59], v[58:59], v[104:105]
    s_waitcnt lgkmcnt(0)
    v_pk_fma_f32 v[52:53], v[52:53], v[108:109], v[116:117]
    s_mov_b64 exec, s[60:61]
    buffer_load_dwordx4 a[60:63], v6, s[12:15], s49 offen offset:3072
    s_mov_b64 exec, -1
    v_pk_fma_f32 v[54:55], v[54:55], v[110:111], v[118:119]
    v_pk_fma_f32 v[56:57], v[56:57], v[112:113], v[120:121]
    v_pk_fma_f32 v[58:59], v[58:59], v[114:115], v[122:123]
    v_cvt_pk_bf16_f32 v20, v52, v53
    v_cvt_pk_bf16_f32 v21, v54, v55
    v_cvt_pk_bf16_f32 v22, v56, v57
    v_cvt_pk_bf16_f32 v23, v58, v59
    ds_write_b128 v7, v[20:23] offset:8192
    ds_read_b128 v[108:111], v106 offset:59648
    ds_read_b128 v[112:115], v106 offset:59664
    ds_read_b128 v[116:119], v106 offset:57856
    ds_read_b128 v[120:123], v106 offset:57872
    v_pk_mul_f32 v[60:61], v[60:61], v[104:105]
    v_pk_mul_f32 v[62:63], v[62:63], v[104:105]
    v_pk_mul_f32 v[64:65], v[64:65], v[104:105]
    v_pk_mul_f32 v[66:67], v[66:67], v[104:105]
    s_mov_b64 exec, s[60:61]
    buffer_load_dwordx4 a[64:67], v6, s[12:15], s46 offen offset:0
    s_mov_b64 exec, -1
    s_waitcnt lgkmcnt(0)
    v_pk_fma_f32 v[60:61], v[60:61], v[108:109], v[116:117]
    v_pk_fma_f32 v[62:63], v[62:63], v[110:111], v[118:119]
    v_pk_fma_f32 v[64:65], v[64:65], v[112:113], v[120:121]
    v_pk_fma_f32 v[66:67], v[66:67], v[114:115], v[122:123]
    v_cvt_pk_bf16_f32 v24, v60, v61
    v_cvt_pk_bf16_f32 v25, v62, v63
    v_cvt_pk_bf16_f32 v26, v64, v65
    v_cvt_pk_bf16_f32 v27, v66, v67
    ds_write_b128 v7, v[24:27] offset:16384
    ds_read_b128 v[108:111], v106 offset:59904
    ds_read_b128 v[112:115], v106 offset:59920
    ds_read_b128 v[116:119], v106 offset:58112
    ds_read_b128 v[120:123], v106 offset:58128
    v_pk_mul_f32 v[68:69], v[68:69], v[104:105]
    v_pk_mul_f32 v[70:71], v[70:71], v[104:105]
    s_mov_b64 exec, s[60:61]
    buffer_load_dwordx4 a[68:71], v6, s[12:15], s50 offen offset:0
    s_mov_b64 exec, -1
    v_pk_mul_f32 v[72:73], v[72:73], v[104:105]
    v_pk_mul_f32 v[74:75], v[74:75], v[104:105]
    s_waitcnt lgkmcnt(0)
    v_pk_fma_f32 v[68:69], v[68:69], v[108:109], v[116:117]
    v_pk_fma_f32 v[70:71], v[70:71], v[110:111], v[118:119]
    v_pk_fma_f32 v[72:73], v[72:73], v[112:113], v[120:121]
    v_pk_fma_f32 v[74:75], v[74:75], v[114:115], v[122:123]
    v_cvt_pk_bf16_f32 v28, v68, v69
    v_cvt_pk_bf16_f32 v29, v70, v71
    v_cvt_pk_bf16_f32 v30, v72, v73
    v_cvt_pk_bf16_f32 v31, v74, v75
    ds_write_b128 v7, v[28:31] offset:24576
    ds_read_b128 v[108:111], v106 offset:60160
    ds_read_b128 v[112:115], v106 offset:60176
    ds_read_b128 v[116:119], v106 offset:58368
    ds_read_b128 v[120:123], v106 offset:58384
    s_mov_b64 exec, s[60:61]
    buffer_load_dwordx4 a[72:75], v6, s[12:15], s46 offen offset:1024
    s_mov_b64 exec, -1
    v_pk_mul_f32 v[76:77], v[76:77], v[104:105]
    v_pk_mul_f32 v[78:79], v[78:79], v[104:105]
    v_pk_mul_f32 v[80:81], v[80:81], v[104:105]
    v_pk_mul_f32 v[82:83], v[82:83], v[104:105]
    s_waitcnt lgkmcnt(0)
    v_pk_fma_f32 v[76:77], v[76:77], v[108:109], v[116:117]
    v_pk_fma_f32 v[78:79], v[78:79], v[110:111], v[118:119]
    v_pk_fma_f32 v[80:81], v[80:81], v[112:113], v[120:121]
    v_pk_fma_f32 v[82:83], v[82:83], v[114:115], v[122:123]
    v_cvt_pk_bf16_f32 v32, v76, v77
    v_cvt_pk_bf16_f32 v33, v78, v79
    v_cvt_pk_bf16_f32 v34, v80, v81
    v_cvt_pk_bf16_f32 v35, v82, v83
    ds_write_b128 v7, v[32:35] offset:32768
    ds_read_b128 v[108:111], v106 offset:60416
    ds_read_b128 v[112:115], v106 offset:60432
    s_mov_b64 exec, s[60:61]
    buffer_load_dwordx4 a[76:79], v6, s[12:15], s50 offen offset:1024
    s_mov_b64 exec, -1
    ds_read_b128 v[116:119], v106 offset:58624
    ds_read_b128 v[120:123], v106 offset:58640
    v_pk_mul_f32 v[84:85], v[84:85], v[104:105]
    v_pk_mul_f32 v[86:87], v[86:87], v[104:105]
    v_pk_mul_f32 v[88:89], v[88:89], v[104:105]
    v_pk_mul_f32 v[90:91], v[90:91], v[104:105]
    s_waitcnt lgkmcnt(0)
    v_pk_fma_f32 v[84:85], v[84:85], v[108:109], v[116:117]
    v_pk_fma_f32 v[86:87], v[86:87], v[110:111], v[118:119]
    v_pk_fma_f32 v[88:89], v[88:89], v[112:113], v[120:121]
    v_pk_fma_f32 v[90:91], v[90:91], v[114:115], v[122:123]
    v_cvt_pk_bf16_f32 v36, v84, v85
    v_cvt_pk_bf16_f32 v37, v86, v87
    v_cvt_pk_bf16_f32 v38, v88, v89
    v_cvt_pk_bf16_f32 v39, v90, v91
    ds_write_b128 v7, v[36:39] offset:40960
    ds_read_b128 v[108:111], v106 offset:60672
    ds_read_b128 v[112:115], v106 offset:60688
    ds_read_b128 v[116:119], v106 offset:58880
    ds_read_b128 v[120:123], v106 offset:58896
    v_pk_mul_f32 v[92:93], v[92:93], v[104:105]
    v_pk_mul_f32 v[94:95], v[94:95], v[104:105]
    v_pk_mul_f32 v[96:97], v[96:97], v[104:105]
    v_pk_mul_f32 v[98:99], v[98:99], v[104:105]
    s_waitcnt lgkmcnt(0)
    v_pk_fma_f32 v[92:93], v[92:93], v[108:109], v[116:117]
    v_pk_fma_f32 v[94:95], v[94:95], v[110:111], v[118:119]
    v_pk_fma_f32 v[96:97], v[96:97], v[112:113], v[120:121]
    v_pk_fma_f32 v[98:99], v[98:99], v[114:115], v[122:123]
    v_cvt_pk_bf16_f32 v40, v92, v93
    v_cvt_pk_bf16_f32 v41, v94, v95
    v_cvt_pk_bf16_f32 v42, v96, v97
    v_cvt_pk_bf16_f32 v43, v98, v99
    ds_write_b128 v7, v[40:43] offset:49152
    v_and_b32 v8, 15, v0
    v_bfe_u32 v9, v0, 4, 2
    v_and_b32 v12, 7, v8
    v_xor_b32 v13, v12, v9
    v_lshlrev_b32 v14, 7, v8
    v_lshl_add_u32 v10, v13, 4, v14
    v_xor_b32 v13, 4, v13
    v_lshl_add_u32 v11, v13, 4, v14
    s_waitcnt lgkmcnt(0)
    s_barrier
    s_cmp_eq_u32 s33, 7
    s_cbranch_scc1 L_k5_exit
    ds_read_b128 v[76:79], v10 offset:0
    ds_read_b128 v[80:83], v10 offset:2048
    ds_read_b128 v[84:87], v10 offset:4096
    ds_read_b128 v[88:91], v10 offset:6144
    buffer_load_dwordx4 a[80:83], v6, s[12:15], s46 offen offset:2048
    buffer_load_dwordx4 a[84:87], v6, s[12:15], s50 offen offset:2048
    ds_read_b128 v[92:95], v11 offset:0
    ds_read_b128 v[96:99], v11 offset:2048
    ds_read_b128 v[100:103], v11 offset:4096
    ds_read_b128 v[104:107], v11 offset:6144
    s_waitcnt vmcnt(20) lgkmcnt(4)
    v_mfma_f32_16x16x32_bf16 v[44:47], a[0:3], v[76:79], 0
    v_mfma_f32_16x16x32_bf16 v[48:51], a[0:3], v[80:83], 0
    v_mfma_f32_16x16x32_bf16 v[52:55], a[0:3], v[84:87], 0
    v_mfma_f32_16x16x32_bf16 v[56:59], a[0:3], v[88:91], 0
    v_mfma_f32_16x16x32_bf16 v[60:63], a[4:7], v[76:79], 0
    v_mfma_f32_16x16x32_bf16 v[64:67], a[4:7], v[80:83], 0
    v_mfma_f32_16x16x32_bf16 v[68:71], a[4:7], v[84:87], 0
    v_mfma_f32_16x16x32_bf16 v[72:75], a[4:7], v[88:91], 0
    buffer_load_dwordx4 a[88:91], v6, s[12:15], s46 offen offset:3072
    buffer_load_dwordx4 a[92:95], v6, s[12:15], s50 offen offset:3072
    ds_read_b128 v[76:79], v10 offset:8192
    ds_read_b128 v[80:83], v10 offset:10240
    ds_read_b128 v[84:87], v10 offset:12288
    ds_read_b128 v[88:91], v10 offset:14336
    s_waitcnt vmcnt(20) lgkmcnt(4)
    v_mfma_f32_16x16x32_bf16 v[44:47], a[8:11], v[92:95], v[44:47]
    v_mfma_f32_16x16x32_bf16 v[48:51], a[8:11], v[96:99], v[48:51]
    v_mfma_f32_16x16x32_bf16 v[52:55], a[8:11], v[100:103], v[52:55]
    v_mfma_f32_16x16x32_bf16 v[56:59], a[8:11], v[104:107], v[56:59]
    v_mfma_f32_16x16x32_bf16 v[60:63], a[12:15], v[92:95], v[60:63]
    v_mfma_f32_16x16x32_bf16 v[64:67], a[12:15], v[96:99], v[64:67]
    v_mfma_f32_16x16x32_bf16 v[68:71], a[12:15], v[100:103], v[68:71]
    v_mfma_f32_16x16x32_bf16 v[72:75], a[12:15], v[104:107], v[72:75]
    buffer_load_dwordx4 a[96:99], v6, s[12:15], s47 offen offset:0
    buffer_load_dwordx4 a[100:103], v6, s[12:15], s51 offen offset:0
    ds_read_b128 v[92:95], v11 offset:8192
    ds_read_b128 v[96:99], v11 offset:10240
    ds_read_b128 v[100:103], v11 offset:12288
    ds_read_b128 v[104:107], v11 offset:14336
    s_waitcnt vmcnt(20) lgkmcnt(4)
    v_mfma_f32_16x16x32_bf16 v[44:47], a[16:19], v[76:79], v[44:47]
    v_mfma_f32_16x16x32_bf16 v[48:51], a[16:19], v[80:83], v[48:51]
    v_mfma_f32_16x16x32_bf16 v[52:55], a[16:19], v[84:87], v[52:55]
    v_mfma_f32_16x16x32_bf16 v[56:59], a[16:19], v[88:91], v[56:59]
    v_mfma_f32_16x16x32_bf16 v[60:63], a[20:23], v[76:79], v[60:63]
    v_mfma_f32_16x16x32_bf16 v[64:67], a[20:23], v[80:83], v[64:67]
    v_mfma_f32_16x16x32_bf16 v[68:71], a[20:23], v[84:87], v[68:71]
    v_mfma_f32_16x16x32_bf16 v[72:75], a[20:23], v[88:91], v[72:75]
    buffer_load_dwordx4 a[104:107], v6, s[12:15], s47 offen offset:1024
    buffer_load_dwordx4 a[108:111], v6, s[12:15], s51 offen offset:1024
    ds_read_b128 v[76:79], v10 offset:16384
    ds_read_b128 v[80:83], v10 offset:18432
    ds_read_b128 v[84:87], v10 offset:20480
    ds_read_b128 v[88:91], v10 offset:22528
    s_waitcnt vmcnt(20) lgkmcnt(4)
    v_mfma_f32_16x16x32_bf16 v[44:47], a[24:27], v[92:95], v[44:47]
    v_mfma_f32_16x16x32_bf16 v[48:51], a[24:27], v[96:99], v[48:51]
    v_mfma_f32_16x16x32_bf16 v[52:55], a[24:27], v[100:103], v[52:55]
    v_mfma_f32_16x16x32_bf16 v[56:59], a[24:27], v[104:107], v[56:59]
    v_mfma_f32_16x16x32_bf16 v[60:63], a[28:31], v[92:95], v[60:63]
    v_mfma_f32_16x16x32_bf16 v[64:67], a[28:31], v[96:99], v[64:67]
    v_mfma_f32_16x16x32_bf16 v[68:71], a[28:31], v[100:103], v[68:71]
    v_mfma_f32_16x16x32_bf16 v[72:75], a[28:31], v[104:107], v[72:75]
    ds_read_b128 v[92:95], v11 offset:16384
    ds_read_b128 v[96:99], v11 offset:18432
    ds_read_b128 v[100:103], v11 offset:20480
    ds_read_b128 v[104:107], v11 offset:22528
    s_waitcnt vmcnt(18) lgkmcnt(4)
    v_mfma_f32_16x16x32_bf16 v[44:47], a[32:35], v[76:79], v[44:47]
    v_mfma_f32_16x16x32_bf16 v[48:51], a[32:35], v[80:83], v[48:51]
    v_mfma_f32_16x16x32_bf16 v[52:55], a[32:35], v[84:87], v[52:55]
    v_mfma_f32_16x16x32_bf16 v[56:59], a[32:35], v[88:91], v[56:59]
    v_mfma_f32_16x16x32_bf16 v[60:63], a[36:39], v[76:79], v[60:63]
    v_mfma_f32_16x16x32_bf16 v[64:67], a[36:39], v[80:83], v[64:67]
    v_mfma_f32_16x16x32_bf16 v[68:71], a[36:39], v[84:87], v[68:71]
    v_mfma_f32_16x16x32_bf16 v[72:75], a[36:39], v[88:91], v[72:75]
    ds_read_b128 v[76:79], v10 offset:24576
    ds_read_b128 v[80:83], v10 offset:26624
    ds_read_b128 v[84:87], v10 offset:28672
    ds_read_b128 v[88:91], v10 offset:30720
    s_waitcnt vmcnt(16) lgkmcnt(4)
    v_mfma_f32_16x16x32_bf16 v[44:47], a[40:43], v[92:95], v[44:47]
    v_mfma_f32_16x16x32_bf16 v[48:51], a[40:43], v[96:99], v[48:51]
    v_mfma_f32_16x16x32_bf16 v[52:55], a[40:43], v[100:103], v[52:55]
    v_mfma_f32_16x16x32_bf16 v[56:59], a[40:43], v[104:107], v[56:59]
    v_mfma_f32_16x16x32_bf16 v[60:63], a[44:47], v[92:95], v[60:63]
    v_mfma_f32_16x16x32_bf16 v[64:67], a[44:47], v[96:99], v[64:67]
    v_mfma_f32_16x16x32_bf16 v[68:71], a[44:47], v[100:103], v[68:71]
    v_mfma_f32_16x16x32_bf16 v[72:75], a[44:47], v[104:107], v[72:75]
    ds_read_b128 v[92:95], v11 offset:24576
    ds_read_b128 v[96:99], v11 offset:26624
    ds_read_b128 v[100:103], v11 offset:28672
    ds_read_b128 v[104:107], v11 offset:30720
    s_waitcnt vmcnt(14) lgkmcnt(4)
    v_mfma_f32_16x16x32_bf16 v[44:47], a[48:51], v[76:79], v[44:47]
    v_mfma_f32_16x16x32_bf16 v[48:51], a[48:51], v[80:83], v[48:51]
    v_mfma_f32_16x16x32_bf16 v[52:55], a[48:51], v[84:87], v[52:55]
    v_mfma_f32_16x16x32_bf16 v[56:59], a[48:51], v[88:91], v[56:59]
    v_mfma_f32_16x16x32_bf16 v[60:63], a[52:55], v[76:79], v[60:63]
    v_mfma_f32_16x16x32_bf16 v[64:67], a[52:55], v[80:83], v[64:67]
    v_mfma_f32_16x16x32_bf16 v[68:71], a[52:55], v[84:87], v[68:71]
    v_mfma_f32_16x16x32_bf16 v[72:75], a[52:55], v[88:91], v[72:75]
    ds_read_b128 v[76:79], v10 offset:32768
    ds_read_b128 v[80:83], v10 offset:34816
    ds_read_b128 v[84:87], v10 offset:36864
    ds_read_b128 v[88:91], v10 offset:38912
    s_waitcnt vmcnt(12) lgkmcnt(4)
    v_mfma_f32_16x16x32_bf16 v[44:47], a[56:59], v[92:95], v[44:47]
    v_mfma_f32_16x16x32_bf16 v[48:51], a[56:59], v[96:99], v[48:51]
    v_mfma_f32_16x16x32_bf16 v[52:55], a[56:59], v[100:103], v[52:55]
    v_mfma_f32_16x16x32_bf16 v[56:59], a[56:59], v[104:107], v[56:59]
    v_mfma_f32_16x16x32_bf16 v[60:63], a[60:63], v[92:95], v[60:63]
    v_mfma_f32_16x16x32_bf16 v[64:67], a[60:63], v[96:99], v[64:67]
    v_mfma_f32_16x16x32_bf16 v[68:71], a[60:63], v[100:103], v[68:71]
    v_mfma_f32_16x16x32_bf16 v[72:75], a[60:63], v[104:107], v[72:75]
    ds_read_b128 v[92:95], v11 offset:32768
    ds_read_b128 v[96:99], v11 offset:34816
    ds_read_b128 v[100:103], v11 offset:36864
    ds_read_b128 v[104:107], v11 offset:38912
    s_waitcnt vmcnt(10) lgkmcnt(4)
    v_mfma_f32_16x16x32_bf16 v[44:47], a[64:67], v[76:79], v[44:47]
    v_mfma_f32_16x16x32_bf16 v[48:51], a[64:67], v[80:83], v[48:51]
    v_mfma_f32_16x16x32_bf16 v[52:55], a[64:67], v[84:87], v[52:55]
    v_mfma_f32_16x16x32_bf16 v[56:59], a[64:67], v[88:91], v[56:59]
    v_mfma_f32_16x16x32_bf16 v[60:63], a[68:71], v[76:79], v[60:63]
    v_mfma_f32_16x16x32_bf16 v[64:67], a[68:71], v[80:83], v[64:67]
    v_mfma_f32_16x16x32_bf16 v[68:71], a[68:71], v[84:87], v[68:71]
    v_mfma_f32_16x16x32_bf16 v[72:75], a[68:71], v[88:91], v[72:75]
    ds_read_b128 v[76:79], v10 offset:40960
    ds_read_b128 v[80:83], v10 offset:43008
    ds_read_b128 v[84:87], v10 offset:45056
    ds_read_b128 v[88:91], v10 offset:47104
    s_waitcnt vmcnt(8) lgkmcnt(4)
    v_mfma_f32_16x16x32_bf16 v[44:47], a[72:75], v[92:95], v[44:47]
    v_mfma_f32_16x16x32_bf16 v[48:51], a[72:75], v[96:99], v[48:51]
    v_mfma_f32_16x16x32_bf16 v[52:55], a[72:75], v[100:103], v[52:55]
    v_mfma_f32_16x16x32_bf16 v[56:59], a[72:75], v[104:107], v[56:59]
    v_mfma_f32_16x16x32_bf16 v[60:63], a[76:79], v[92:95], v[60:63]
    v_mfma_f32_16x16x32_bf16 v[64:67], a[76:79], v[96:99], v[64:67]
    v_mfma_f32_16x16x32_bf16 v[68:71], a[76:79], v[100:103], v[68:71]
    v_mfma_f32_16x16x32_bf16 v[72:75], a[76:79], v[104:107], v[72:75]
    ds_read_b128 v[92:95], v11 offset:40960
    ds_read_b128 v[96:99], v11 offset:43008
    ds_read_b128 v[100:103], v11 offset:45056
    ds_read_b128 v[104:107], v11 offset:47104
    s_waitcnt vmcnt(6) lgkmcnt(4)
    v_mfma_f32_16x16x32_bf16 v[44:47], a[80:83], v[76:79], v[44:47]
    v_mfma_f32_16x16x32_bf16 v[48:51], a[80:83], v[80:83], v[48:51]
    v_mfma_f32_16x16x32_bf16 v[52:55], a[80:83], v[84:87], v[52:55]
    v_mfma_f32_16x16x32_bf16 v[56:59], a[80:83], v[88:91], v[56:59]
    v_mfma_f32_16x16x32_bf16 v[60:63], a[84:87], v[76:79], v[60:63]
    v_mfma_f32_16x16x32_bf16 v[64:67], a[84:87], v[80:83], v[64:67]
    v_mfma_f32_16x16x32_bf16 v[68:71], a[84:87], v[84:87], v[68:71]
    v_mfma_f32_16x16x32_bf16 v[72:75], a[84:87], v[88:91], v[72:75]
    ds_read_b128 v[76:79], v10 offset:49152
    ds_read_b128 v[80:83], v10 offset:51200
    ds_read_b128 v[84:87], v10 offset:53248
    ds_read_b128 v[88:91], v10 offset:55296
    s_waitcnt vmcnt(4) lgkmcnt(4)
    v_mfma_f32_16x16x32_bf16 v[44:47], a[88:91], v[92:95], v[44:47]
    v_mfma_f32_16x16x32_bf16 v[48:51], a[88:91], v[96:99], v[48:51]
    v_mfma_f32_16x16x32_bf16 v[52:55], a[88:91], v[100:103], v[52:55]
    v_mfma_f32_16x16x32_bf16 v[56:59], a[88:91], v[104:107], v[56:59]
    v_mfma_f32_16x16x32_bf16 v[60:63], a[92:95], v[92:95], v[60:63]
    v_mfma_f32_16x16x32_bf16 v[64:67], a[92:95], v[96:99], v[64:67]
    v_mfma_f32_16x16x32_bf16 v[68:71], a[92:95], v[100:103], v[68:71]
    v_mfma_f32_16x16x32_bf16 v[72:75], a[92:95], v[104:107], v[72:75]
    ds_read_b128 v[92:95], v11 offset:49152
    ds_read_b128 v[96:99], v11 offset:51200
    ds_read_b128 v[100:103], v11 offset:53248
    ds_read_b128 v[104:107], v11 offset:55296
    s_waitcnt vmcnt(2) lgkmcnt(4)
    v_mfma_f32_16x16x32_bf16 v[44:47], a[96:99], v[76:79], v[44:47]
    v_mfma_f32_16x16x32_bf16 v[48:51], a[96:99], v[80:83], v[48:51]
    v_mfma_f32_16x16x32_bf16 v[52:55], a[96:99], v[84:87], v[52:55]
    v_mfma_f32_16x16x32_bf16 v[56:59], a[96:99], v[88:91], v[56:59]
    v_mfma_f32_16x16x32_bf16 v[60:63], a[100:103], v[76:79], v[60:63]
    v_mfma_f32_16x16x32_bf16 v[64:67], a[100:103], v[80:83], v[64:67]
    v_mfma_f32_16x16x32_bf16 v[68:71], a[100:103], v[84:87], v[68:71]
    v_mfma_f32_16x16x32_bf16 v[72:75], a[100:103], v[88:91], v[72:75]
    s_waitcnt vmcnt(0) lgkmcnt(0)
    v_mfma_f32_16x16x32_bf16 v[44:47], a[104:107], v[92:95], v[44:47]
    v_mfma_f32_16x16x32_bf16 v[48:51], a[104:107], v[96:99], v[48:51]
    v_mfma_f32_16x16x32_bf16 v[52:55], a[104:107], v[100:103], v[52:55]
    v_mfma_f32_16x16x32_bf16 v[56:59], a[104:107], v[104:107], v[56:59]
    v_mfma_f32_16x16x32_bf16 v[60:63], a[108:111], v[92:95], v[60:63]
    v_mfma_f32_16x16x32_bf16 v[64:67], a[108:111], v[96:99], v[64:67]
    v_mfma_f32_16x16x32_bf16 v[68:71], a[108:111], v[100:103], v[68:71]
    v_mfma_f32_16x16x32_bf16 v[72:75], a[108:111], v[104:107], v[72:75]
    v_add_u32 v12, s34, v8
    v_mul_u32_u24 v12, 3584, v12
    v_and_b32 v13, 1, v9
    v_lshl_add_u32 v12, v13, 5, v12
    v_lshrrev_b32 v13, 1, v9
    v_lshl_add_u32 v12, v13, 4, v12
    s_lshl_b32 s39, s35, 5
    v_add_u32 v12, s39, v12
    s_nop 2
    v_max_f32 v44, 0, v44
    v_max_f32 v45, 0, v45
    v_max_f32 v46, 0, v46
    v_max_f32 v47, 0, v47
    v_cvt_pk_bf16_f32 v16, v44, v45
    v_cvt_pk_bf16_f32 v17, v46, v47
    v_max_f32 v60, 0, v60
    v_max_f32 v61, 0, v61
    v_max_f32 v62, 0, v62
    v_max_f32 v63, 0, v63
    v_cvt_pk_bf16_f32 v18, v60, v61
    v_cvt_pk_bf16_f32 v19, v62, v63
    s_nop 1
    v_permlane16_swap_b32 v16, v18
    v_permlane16_swap_b32 v17, v19
    s_mov_b32 s38, 0
    buffer_store_dwordx4 v[16:19], v12, s[24:27], s38 offen sc1
    v_max_f32 v48, 0, v48
    v_max_f32 v49, 0, v49
    v_max_f32 v50, 0, v50
    v_max_f32 v51, 0, v51
    v_cvt_pk_bf16_f32 v20, v48, v49
    v_cvt_pk_bf16_f32 v21, v50, v51
    v_max_f32 v64, 0, v64
    v_max_f32 v65, 0, v65
    v_max_f32 v66, 0, v66
    v_max_f32 v67, 0, v67
    v_cvt_pk_bf16_f32 v22, v64, v65
    v_cvt_pk_bf16_f32 v23, v66, v67
    s_nop 1
    v_permlane16_swap_b32 v20, v22
    v_permlane16_swap_b32 v21, v23
    s_mov_b32 s38, 57344
    buffer_store_dwordx4 v[20:23], v12, s[24:27], s38 offen sc1
    v_max_f32 v52, 0, v52
    v_max_f32 v53, 0, v53
    v_max_f32 v54, 0, v54
    v_max_f32 v55, 0, v55
    v_cvt_pk_bf16_f32 v24, v52, v53
    v_cvt_pk_bf16_f32 v25, v54, v55
    v_max_f32 v68, 0, v68
    v_max_f32 v69, 0, v69
    v_max_f32 v70, 0, v70
    v_max_f32 v71, 0, v71
    v_cvt_pk_bf16_f32 v26, v68, v69
    v_cvt_pk_bf16_f32 v27, v70, v71
    s_nop 1
    v_permlane16_swap_b32 v24, v26
    v_permlane16_swap_b32 v25, v27
    s_mov_b32 s38, 114688
    buffer_store_dwordx4 v[24:27], v12, s[24:27], s38 offen sc1
    v_max_f32 v56, 0, v56
    v_max_f32 v57, 0, v57
    v_max_f32 v58, 0, v58
    v_max_f32 v59, 0, v59
    v_cvt_pk_bf16_f32 v28, v56, v57
    v_cvt_pk_bf16_f32 v29, v58, v59
    v_max_f32 v72, 0, v72
    v_max_f32 v73, 0, v73
    v_max_f32 v74, 0, v74
    v_max_f32 v75, 0, v75
    v_cvt_pk_bf16_f32 v30, v72, v73
    v_cvt_pk_bf16_f32 v31, v74, v75
    s_nop 1
    v_permlane16_swap_b32 v28, v30
    v_permlane16_swap_b32 v29, v31
    s_mov_b32 s38, 172032
    buffer_store_dwordx4 v[28:31], v12, s[24:27], s38 offen sc1
L_k5_exit:
    s_endpgm
    .globl k6_kernel
    .p2align 8
    .type k6_kernel,@function
k6_kernel:
    s_load_dwordx2 s[4:5], s[0:1], 80
    s_load_dwordx2 s[6:7], s[0:1], 64
    s_cmp_ge_u32 s2, 224
    s_cbranch_scc1 L_k6_kernel_exit
    v_lshrrev_b32 v1, 6, v0
    s_nop 0
    v_readfirstlane_b32 s33, v1
    s_and_b32 s34, s2, 31
    s_lshr_b32 s35, s2, 5
    s_lshl_b32 s34, s34, 6
    s_lshl_b32 s35, s35, 2
    s_and_b32 s44, s33, 1
    s_lshr_b32 s45, s33, 1
    s_lshl_b32 s36, s44, 1
    s_add_u32 s35, s35, s36
    v_and_b32 v2, 63, v0
    v_and_b32 v8, 15, v0
    v_bfe_u32 v9, v0, 4, 2
    v_lshrrev_b32 v3, 3, v2
    v_and_b32 v4, 7, v2
    v_xor_b32 v4, v4, v3
    s_lshl_b32 s36, s33, 3
    s_add_u32 s36, s36, s34
    v_add_u32 v5, s36, v3
    v_mul_u32_u24 v5, 3584, v5
    v_lshl_add_u32 v16, v4, 4, v5
    s_waitcnt lgkmcnt(0)
    s_add_u32 s8, s4, 18874368
    s_addc_u32 s9, s5, 0
    s_and_b32 s9, s9, 0xffff
    s_mov_b32 s10, 7340032
    s_mov_b32 s11, 0x00020000
    s_add_u32 s12, s4, 6291456
    s_addc_u32 s13, s5, 0
    s_and_b32 s13, s13, 0xffff
    s_mov_b32 s14, 1605632
    s_mov_b32 s15, 0x00020000
    s_mov_b32 s16, s4
    s_and_b32 s17, s5, 0xffff
    s_mov_b32 s18, 10752
    s_mov_b32 s19, 0x00020000
    s_add_u32 s20, s4, 16777216
    s_addc_u32 s21, s5, 0
    s_and_b32 s21, s21, 0xffff
    s_mov_b32 s22, 1835008
    s_mov_b32 s23, 0x00020000
    s_mov_b32 s24, s6
    s_and_b32 s25, s7, 0xffff
    s_mov_b32 s26, 1835008
    s_mov_b32 s27, 0x00020000
    v_lshlrev_b32 v6, 4, v2
    s_mul_i32 s40, s35, 57344
    s_lshl_b32 s37, s45, 10
    s_add_u32 s40, s40, s37
    s_add_u32 s47, s40, 57344
    s_lshl_b32 s41, s33, 10
    s_mov_b32 s38, 0
    s_add_u32 m0, s41, 0
    s_nop 0
    buffer_load_dwordx4 v16, s[8:11], s38 offen lds
    s_mov_b32 s38, 128
    s_add_u32 m0, s41, 8192
    s_nop 0
    buffer_load_dwordx4 v16, s[8:11], s38 offen lds
    s_mov_b32 s38, 256
    s_add_u32 m0, s41, 16384
    s_nop 0
    buffer_load_dwordx4 v16, s[8:11], s38 offen lds
    s_mov_b32 s38, 384
    s_add_u32 m0, s41, 24576
    s_nop 0
    buffer_load_dwordx4 v16, s[8:11], s38 offen lds
    s_add_u32 s42, s40, 0
    s_add_u32 s43, s47, 0
    s_add_u32 s48, s40, 4096
    s_add_u32 s49, s47, 4096
    buffer_load_dwordx4 a[0:3], v6, s[12:15], s42 offen
    buffer_load_dwordx4 a[4:7], v6, s[12:15], s43 offen
    buffer_load_dwordx4 a[8:11], v6, s[12:15], s48 offen
    buffer_load_dwordx4 a[12:15], v6, s[12:15], s49 offen
    s_mov_b32 s38, 512
    s_add_u32 m0, s41, 32768
    s_nop 0
    buffer_load_dwordx4 v16, s[8:11], s38 offen lds
    s_mov_b32 s38, 640
    s_add_u32 m0, s41, 40960
    s_nop 0
    buffer_load_dwordx4 v16, s[8:11], s38 offen lds
    s_mov_b32 s38, 768
    s_add_u32 m0, s41, 49152
    s_nop 0
    buffer_load_dwordx4 v16, s[8:11], s38 offen lds
    s_mov_b32 s38, 896
    s_add_u32 m0, s41, 57344
    s_nop 0
    buffer_load_dwordx4 v16, s[8:11], s38 offen lds
    s_add_u32 s42, s40, 8192
    s_add_u32 s43, s47, 8192
    s_add_u32 s48, s40, 12288
    s_add_u32 s49, s47, 12288
    buffer_load_dwordx4 a[16:19], v6, s[12:15], s42 offen
    buffer_load_dwordx4 a[20:23], v6, s[12:15], s43 offen
    buffer_load_dwordx4 a[24:27], v6, s[12:15], s48 offen
    buffer_load_dwordx4 a[28:31], v6, s[12:15], s49 offen
    s_lshl_b32 s39, s45, 4
    s_add_u32 s39, s39, s34
    v_add_u32 v11, s39, v8
    v_mul_u32_u24 v11, 896, v11
    s_lshl_b32 s39, s35, 5
    v_add_u32 v11, s39, v11
    v_lshl_add_u32 v13, v9, 3, v11
    v_lshlrev_b32 v12, 4, v9
    s_lshl_b32 s39, s35, 6
    v_add_u32 v12, s39, v12
    s_mov_b32 s39, 8960
    buffer_load_dwordx4 v[20:23], v12, s[16:19], s39 offen
    buffer_load_dwordx4 v[24:27], v12, s[16:19], s39 offen offset:64
    buffer_load_dwordx2 v[28:29], v13, s[20:23], 0 offen
    buffer_load_dwordx2 v[30:31], v13, s[20:23], 0 offen offset:32
    v_and_b32 v13, 1, v9
    v_lshl_add_u32 v11, v13, 5, v11
    v_lshrrev_b32 v13, 1, v9
    v_lshl_add_u32 v11, v13, 4, v11
    s_and_b32 s39, s45, 1
    s_lshl_b32 s39, s39, 2
    v_add_u32 v13, s39, v9
    v_and_b32 v14, 7, v8
    v_xor_b32 v13, v13, v14
    v_lshlrev_b32 v15, 7, v8
    v_lshl_add_u32 v40, v13, 4, v15
    s_lshr_b32 s39, s45, 1
    s_lshl_b32 s39, s39, 13
    v_add_u32 v40, s39, v40
    v_add_u32 v41, 0x10000, v40
    v_add_u32 v42, 0x20000, v40
    s_waitcnt vmcnt(12)
    s_barrier
    s_mov_b32 s38, 1024
    s_add_u32 m0, s41, 65536
    s_nop 0
    buffer_load_dwordx4 v16, s[8:11], s38 offen lds
    s_mov_b32 s38, 1152
    s_add_u32 m0, s41, 73728
    s_nop 0
    buffer_load_dwordx4 v16, s[8:11], s38 offen lds
    s_mov_b32 s38, 1280
    s_add_u32 m0, s41, 81920
    s_nop 0
    buffer_load_dwordx4 v16, s[8:11], s38 offen lds
    s_mov_b32 s38, 1408
    s_add_u32 m0, s41, 90112
    s_nop 0
    buffer_load_dwordx4 v16, s[8:11], s38 offen lds
    s_add_u32 s42, s40, 16384
    s_add_u32 s43, s47, 16384
    s_add_u32 s48, s40, 20480
    s_add_u32 s49, s47, 20480
    buffer_load_dwordx4 a[32:35], v6, s[12:15], s42 offen
    buffer_load_dwordx4 a[36:39], v6, s[12:15], s43 offen
    buffer_load_dwordx4 a[40:43], v6, s[12:15], s48 offen
    buffer_load_dwordx4 a[44:47], v6, s[12:15], s49 offen
    ds_read_b128 v[80:83], v40 offset:0
    ds_read_b128 v[84:87], v40 offset:2048
    ds_read_b128 v[88:91], v40 offset:4096
    ds_read_b128 v[92:95], v40 offset:6144
    ds_read_b128 v[96:99], v40 offset:16384
    ds_read_b128 v[100:103], v40 offset:18432
    ds_read_b128 v[104:107], v40 offset:20480
    ds_read_b128 v[108:111], v40 offset:22528
    s_waitcnt lgkmcnt(4)
    v_mfma_f32_16x16x32_bf16 v[48:51], a[0:3], v[80:83], 0
    v_mfma_f32_16x16x32_bf16 v[52:55], a[0:3], v[84:87], 0
    v_mfma_f32_16x16x32_bf16 v[56:59], a[0:3], v[88:91], 0
    v_mfma_f32_16x16x32_bf16 v[60:63], a[0:3], v[92:95], 0
    v_mfma_f32_16x16x32_bf16 v[64:67], a[4:7], v[80:83], 0
    v_mfma_f32_16x16x32_bf16 v[68:71], a[4:7], v[84:87], 0
    v_mfma_f32_16x16x32_bf16 v[72:75], a[4:7], v[88:91], 0
    v_mfma_f32_16x16x32_bf16 v[76:79], a[4:7], v[92:95], 0
    s_waitcnt lgkmcnt(0)
    v_mfma_f32_16x16x32_bf16 v[48:51], a[8:11], v[96:99], v[48:51]
    v_mfma_f32_16x16x32_bf16 v[52:55], a[8:11], v[100:103], v[52:55]
    v_mfma_f32_16x16x32_bf16 v[56:59], a[8:11], v[104:107], v[56:59]
    v_mfma_f32_16x16x32_bf16 v[60:63], a[8:11], v[108:111], v[60:63]
    v_mfma_f32_16x16x32_bf16 v[64:67], a[12:15], v[96:99], v[64:67]
    v_mfma_f32_16x16x32_bf16 v[68:71], a[12:15], v[100:103], v[68:71]
    v_mfma_f32_16x16x32_bf16 v[72:75], a[12:15], v[104:107], v[72:75]
    v_mfma_f32_16x16x32_bf16 v[76:79], a[12:15], v[108:111], v[76:79]
    s_waitcnt vmcnt(12)
    s_barrier
    s_mov_b32 s38, 1536
    s_add_u32 m0, s41, 0
    s_nop 0
    buffer_load_dwordx4 v16, s[8:11], s38 offen lds
    s_mov_b32 s38, 1664
    s_add_u32 m0, s41, 8192
    s_nop 0
    buffer_load_dwordx4 v16, s[8:11], s38 offen lds
    s_mov_b32 s38, 1792
    s_add_u32 m0, s41, 16384
    s_nop 0
    buffer_load_dwordx4 v16, s[8:11], s38 offen lds
    s_mov_b32 s38, 1920
    s_add_u32 m0, s41, 24576
    s_nop 0
    buffer_load_dwordx4 v16, s[8:11], s38 offen lds
    s_add_u32 s42, s40, 24576
    s_add_u32 s43, s47, 24576
    s_add_u32 s48, s40, 28672
    s_add_u32 s49, s47, 28672
    buffer_load_dwordx4 a[48:51], v6, s[12:15], s42 offen
    buffer_load_dwordx4 a[52:55], v6, s[12:15], s43 offen
    buffer_load_dwordx4 a[56:59], v6, s[12:15], s48 offen
    buffer_load_dwordx4 a[60:63], v6, s[12:15], s49 offen
    ds_read_b128 v[80:83], v40 offset:32768
    ds_read_b128 v[84:87], v40 offset:34816
    ds_read_b128 v[88:91], v40 offset:36864
    ds_read_b128 v[92:95], v40 offset:38912
    ds_read_b128 v[96:99], v40 offset:49152
    ds_read_b128 v[100:103], v40 offset:51200
    ds_read_b128 v[104:107], v40 offset:53248
    ds_read_b128 v[108:111], v40 offset:55296
    s_waitcnt lgkmcnt(4)
    v_mfma_f32_16x16x32_bf16 v[48:51], a[16:19], v[80:83], v[48:51]
    v_mfma_f32_16x16x32_bf16 v[52:55], a[16:19], v[84:87], v[52:55]
    v_mfma_f32_16x16x32_bf16 v[56:59], a[16:19], v[88:91], v[56:59]
    v_mfma_f32_16x16x32_bf16 v[60:63], a[16:19], v[92:95], v[60:63]
    v_mfma_f32_16x16x32_bf16 v[64:67], a[20:23], v[80:83], v[64:67]
    v_mfma_f32_16x16x32_bf16 v[68:71], a[20:23], v[84:87], v[68:71]
    v_mfma_f32_16x16x32_bf16 v[72:75], a[20:23], v[88:91], v[72:75]
    v_mfma_f32_16x16x32_bf16 v[76:79], a[20:23], v[92:95], v[76:79]
    s_waitcnt lgkmcnt(0)
    v_mfma_f32_16x16x32_bf16 v[48:51], a[24:27], v[96:99], v[48:51]
    v_mfma_f32_16x16x32_bf16 v[52:55], a[24:27], v[100:103], v[52:55]
    v_mfma_f32_16x16x32_bf16 v[56:59], a[24:27], v[104:107], v[56:59]
    v_mfma_f32_16x16x32_bf16 v[60:63], a[24:27], v[108:111], v[60:63]
    v_mfma_f32_16x16x32_bf16 v[64:67], a[28:31], v[96:99], v[64:67]
    v_mfma_f32_16x16x32_bf16 v[68:71], a[28:31], v[100:103], v[68:71]
    v_mfma_f32_16x16x32_bf16 v[72:75], a[28:31], v[104:107], v[72:75]
    v_mfma_f32_16x16x32_bf16 v[76:79], a[28:31], v[108:111], v[76:79]
    s_waitcnt vmcnt(8)
    s_barrier
    s_mov_b32 s38, 2048
    s_add_u32 m0, s41, 32768
    s_nop 0
    buffer_load_dwordx4 v16, s[8:11], s38 offen lds
    s_mov_b32 s38, 2176
    s_add_u32 m0, s41, 40960
    s_nop 0
    buffer_load_dwordx4 v16, s[8:11], s38 offen lds
    s_mov_b32 s38, 2304
    s_add_u32 m0, s41, 49152
    s_nop 0
    buffer_load_dwordx4 v16, s[8:11], s38 offen lds
    s_mov_b32 s38, 2432
    s_add_u32 m0, s41, 57344
    s_nop 0
    buffer_load_dwordx4 v16, s[8:11], s38 offen lds
    s_add_u32 s42, s40, 32768
    s_add_u32 s43, s47, 32768
    s_add_u32 s48, s40, 36864
    s_add_u32 s49, s47, 36864
    buffer_load_dwordx4 a[64:67], v6, s[12:15], s42 offen
    buffer_load_dwordx4 a[68:71], v6, s[12:15], s43 offen
    buffer_load_dwordx4 a[72:75], v6, s[12:15], s48 offen
    buffer_load_dwordx4 a[76:79], v6, s[12:15], s49 offen
    ds_read_b128 v[80:83], v41 offset:0
    ds_read_b128 v[84:87], v41 offset:2048
    ds_read_b128 v[88:91], v41 offset:4096
    ds_read_b128 v[92:95], v41 offset:6144
    ds_read_b128 v[96:99], v41 offset:16384
    ds_read_b128 v[100:103], v41 offset:18432
    ds_read_b128 v[104:107], v41 offset:20480
    ds_read_b128 v[108:111], v41 offset:22528
    s_waitcnt lgkmcnt(4)
    v_mfma_f32_16x16x32_bf16 v[48:51], a[32:35], v[80:83], v[48:51]
    v_mfma_f32_16x16x32_bf16 v[52:55], a[32:35], v[84:87], v[52:55]
    v_mfma_f32_16x16x32_bf16 v[56:59], a[32:35], v[88:91], v[56:59]
    v_mfma_f32_16x16x32_bf16 v[60:63], a[32:35], v[92:95], v[60:63]
    v_mfma_f32_16x16x32_bf16 v[64:67], a[36:39], v[80:83], v[64:67]
    v_mfma_f32_16x16x32_bf16 v[68:71], a[36:39], v[84:87], v[68:71]
    v_mfma_f32_16x16x32_bf16 v[72:75], a[36:39], v[88:91], v[72:75]
    v_mfma_f32_16x16x32_bf16 v[76:79], a[36:39], v[92:95], v[76:79]
    s_waitcnt lgkmcnt(0)
    v_mfma_f32_16x16x32_bf16 v[48:51], a[40:43], v[96:99], v[48:51]
    v_mfma_f32_16x16x32_bf16 v[52:55], a[40:43], v[100:103], v[52:55]
    v_mfma_f32_16x16x32_bf16 v[56:59], a[40:43], v[104:107], v[56:59]
    v_mfma_f32_16x16x32_bf16 v[60:63], a[40:43], v[108:111], v[60:63]
    v_mfma_f32_16x16x32_bf16 v[64:67], a[44:47], v[96:99], v[64:67]
    v_mfma_f32_16x16x32_bf16 v[68:71], a[44:47], v[100:103], v[68:71]
    v_mfma_f32_16x16x32_bf16 v[72:75], a[44:47], v[104:107], v[72:75]
    v_mfma_f32_16x16x32_bf16 v[76:79], a[44:47], v[108:111], v[76:79]
    s_waitcnt vmcnt(8)
    s_barrier
    s_mov_b32 s38, 2560
    s_add_u32 m0, s41, 65536
    s_nop 0
    buffer_load_dwordx4 v16, s[8:11], s38 offen lds
    s_mov_b32 s38, 2688
    s_add_u32 m0, s41, 73728
    s_nop 0
    buffer_load_dwordx4 v16, s[8:11], s38 offen lds
    s_mov_b32 s38, 2816
    s_add_u32 m0, s41, 81920
    s_nop 0
    buffer_load_dwordx4 v16, s[8:11], s38 offen lds
    s_mov_b32 s38, 2944
    s_add_u32 m0, s41, 90112
    s_nop 0
    buffer_load_dwordx4 v16, s[8:11], s38 offen lds
    s_add_u32 s42, s40, 40960
    s_add_u32 s43, s47, 40960
    s_add_u32 s48, s40, 45056
    s_add_u32 s49, s47, 45056
    buffer_load_dwordx4 a[80:83], v6, s[12:15], s42 offen
    buffer_load_dwordx4 a[84:87], v6, s[12:15], s43 offen
    buffer_load_dwordx4 a[88:91], v6, s[12:15], s48 offen
    buffer_load_dwordx4 a[92:95], v6, s[12:15], s49 offen
    ds_read_b128 v[80:83], v40 offset:0
    ds_read_b128 v[84:87], v40 offset:2048
    ds_read_b128 v[88:91], v40 offset:4096
    ds_read_b128 v[92:95], v40 offset:6144
    ds_read_b128 v[96:99], v40 offset:16384
    ds_read_b128 v[100:103], v40 offset:18432
    ds_read_b128 v[104:107], v40 offset:20480
    ds_read_b128 v[108:111], v40 offset:22528
    s_waitcnt lgkmcnt(4)
    v_mfma_f32_16x16x32_bf16 v[48:51], a[48:51], v[80:83], v[48:51]
    v_mfma_f32_16x16x32_bf16 v[52:55], a[48:51], v[84:87], v[52:55]
    v_mfma_f32_16x16x32_bf16 v[56:59], a[48:51], v[88:91], v[56:59]
    v_mfma_f32_16x16x32_bf16 v[60:63], a[48:51], v[92:95], v[60:63]
    v_mfma_f32_16x16x32_bf16 v[64:67], a[52:55], v[80:83], v[64:67]
    v_mfma_f32_16x16x32_bf16 v[68:71], a[52:55], v[84:87], v[68:71]
    v_mfma_f32_16x16x32_bf16 v[72:75], a[52:55], v[88:91], v[72:75]
    v_mfma_f32_16x16x32_bf16 v[76:79], a[52:55], v[92:95], v[76:79]
    s_waitcnt lgkmcnt(0)
    v_mfma_f32_16x16x32_bf16 v[48:51], a[56:59], v[96:99], v[48:51]
    v_mfma_f32_16x16x32_bf16 v[52:55], a[56:59], v[100:103], v[52:55]
    v_mfma_f32_16x16x32_bf16 v[56:59], a[56:59], v[104:107], v[56:59]
    v_mfma_f32_16x16x32_bf16 v[60:63], a[56:59], v[108:111], v[60:63]
    v_mfma_f32_16x16x32_bf16 v[64:67], a[60:63], v[96:99], v[64:67]
    v_mfma_f32_16x16x32_bf16 v[68:71], a[60:63], v[100:103], v[68:71]
    v_mfma_f32_16x16x32_bf16 v[72:75], a[60:63], v[104:107], v[72:75]
    v_mfma_f32_16x16x32_bf16 v[76:79], a[60:63], v[108:111], v[76:79]
    s_waitcnt vmcnt(8)
    s_barrier
    s_mov_b32 s38, 3072
    s_add_u32 m0, s41, 0
    s_nop 0
    buffer_load_dwordx4 v16, s[8:11], s38 offen lds
    s_mov_b32 s38, 3200
    s_add_u32 m0, s41, 8192
    s_nop 0
    buffer_load_dwordx4 v16, s[8:11], s38 offen lds
    s_mov_b32 s38, 3328
    s_add_u32 m0, s41, 16384
    s_nop 0
    buffer_load_dwordx4 v16, s[8:11], s38 offen lds
    s_mov_b32 s38, 3456
    s_add_u32 m0, s41, 24576
    s_nop 0
    buffer_load_dwordx4 v16, s[8:11], s38 offen lds
    s_add_u32 s42, s40, 49152
    s_add_u32 s43, s47, 49152
    s_add_u32 s48, s40, 53248
    s_add_u32 s49, s47, 53248
    buffer_load_dwordx4 a[96:99], v6, s[12:15], s42 offen
    buffer_load_dwordx4 a[100:103], v6, s[12:15], s43 offen
    buffer_load_dwordx4 a[104:107], v6, s[12:15], s48 offen
    buffer_load_dwordx4 a[108:111], v6, s[12:15], s49 offen
    ds_read_b128 v[80:83], v40 offset:32768
    ds_read_b128 v[84:87], v40 offset:34816
    ds_read_b128 v[88:91], v40 offset:36864
    ds_read_b128 v[92:95], v40 offset:38912
    ds_read_b128 v[96:99], v40 offset:49152
    ds_read_b128 v[100:103], v40 offset:51200
    ds_read_b128 v[104:107], v40 offset:53248
    ds_read_b128 v[108:111], v40 offset:55296
    s_waitcnt lgkmcnt(4)
    v_mfma_f32_16x16x32_bf16 v[48:51], a[64:67], v[80:83], v[48:51]
    v_mfma_f32_16x16x32_bf16 v[52:55], a[64:67], v[84:87], v[52:55]
    v_mfma_f32_16x16x32_bf16 v[56:59], a[64:67], v[88:91], v[56:59]
    v_mfma_f32_16x16x32_bf16 v[60:63], a[64:67], v[92:95], v[60:63]
    v_mfma_f32_16x16x32_bf16 v[64:67], a[68:71], v[80:83], v[64:67]
    v_mfma_f32_16x16x32_bf16 v[68:71], a[68:71], v[84:87], v[68:71]
    v_mfma_f32_16x16x32_bf16 v[72:75], a[68:71], v[88:91], v[72:75]
    v_mfma_f32_16x16x32_bf16 v[76:79], a[68:71], v[92:95], v[76:79]
    s_waitcnt lgkmcnt(0)
    v_mfma_f32_16x16x32_bf16 v[48:51], a[72:75], v[96:99], v[48:51]
    v_mfma_f32_16x16x32_bf16 v[52:55], a[72:75], v[100:103], v[52:55]
    v_mfma_f32_16x16x32_bf16 v[56:59], a[72:75], v[104:107], v[56:59]
    v_mfma_f32_16x16x32_bf16 v[60:63], a[72:75], v[108:111], v[60:63]
    v_mfma_f32_16x16x32_bf16 v[64:67], a[76:79], v[96:99], v[64:67]
    v_mfma_f32_16x16x32_bf16 v[68:71], a[76:79], v[100:103], v[68:71]
    v_mfma_f32_16x16x32_bf16 v[72:75], a[76:79], v[104:107], v[72:75]
    v_mfma_f32_16x16x32_bf16 v[76:79], a[76:79], v[108:111], v[76:79]
    s_waitcnt vmcnt(8)
    s_barrier
    ds_read_b128 v[80:83], v41 offset:0
    ds_read_b128 v[84:87], v41 offset:2048
    ds_read_b128 v[88:91], v41 offset:4096
    ds_read_b128 v[92:95], v41 offset:6144
    ds_read_b128 v[96:99], v41 offset:16384
    ds_read_b128 v[100:103], v41 offset:18432
    ds_read_b128 v[104:107], v41 offset:20480
    ds_read_b128 v[108:111], v41 offset:22528
    s_waitcnt lgkmcnt(4)
    v_mfma_f32_16x16x32_bf16 v[48:51], a[80:83], v[80:83], v[48:51]
    v_mfma_f32_16x16x32_bf16 v[52:55], a[80:83], v[84:87], v[52:55]
    v_mfma_f32_16x16x32_bf16 v[56:59], a[80:83], v[88:91], v[56:59]
    v_mfma_f32_16x16x32_bf16 v[60:63], a[80:83], v[92:95], v[60:63]
    v_mfma_f32_16x16x32_bf16 v[64:67], a[84:87], v[80:83], v[64:67]
    v_mfma_f32_16x16x32_bf16 v[68:71], a[84:87], v[84:87], v[68:71]
    v_mfma_f32_16x16x32_bf16 v[72:75], a[84:87], v[88:91], v[72:75]
    v_mfma_f32_16x16x32_bf16 v[76:79], a[84:87], v[92:95], v[76:79]
    s_waitcnt lgkmcnt(0)
    v_mfma_f32_16x16x32_bf16 v[48:51], a[88:91], v[96:99], v[48:51]
    v_mfma_f32_16x16x32_bf16 v[52:55], a[88:91], v[100:103], v[52:55]
    v_mfma_f32_16x16x32_bf16 v[56:59], a[88:91], v[104:107], v[56:59]
    v_mfma_f32_16x16x32_bf16 v[60:63], a[88:91], v[108:111], v[60:63]
    v_mfma_f32_16x16x32_bf16 v[64:67], a[92:95], v[96:99], v[64:67]
    v_mfma_f32_16x16x32_bf16 v[68:71], a[92:95], v[100:103], v[68:71]
    v_mfma_f32_16x16x32_bf16 v[72:75], a[92:95], v[104:107], v[72:75]
    v_mfma_f32_16x16x32_bf16 v[76:79], a[92:95], v[108:111], v[76:79]
    s_waitcnt vmcnt(0)
    s_barrier
    ds_read_b128 v[80:83], v40 offset:0
    ds_read_b128 v[84:87], v40 offset:2048
    ds_read_b128 v[88:91], v40 offset:4096
    ds_read_b128 v[92:95], v40 offset:6144
    ds_read_b128 v[96:99], v40 offset:16384
    ds_read_b128 v[100:103], v40 offset:18432
    ds_read_b128 v[104:107], v40 offset:20480
    ds_read_b128 v[108:111], v40 offset:22528
    s_waitcnt lgkmcnt(4)
    v_mfma_f32_16x16x32_bf16 v[48:51], a[96:99], v[80:83], v[48:51]
    v_mfma_f32_16x16x32_bf16 v[52:55], a[96:99], v[84:87], v[52:55]
    v_mfma_f32_16x16x32_bf16 v[56:59], a[96:99], v[88:91], v[56:59]
    v_mfma_f32_16x16x32_bf16 v[60:63], a[96:99], v[92:95], v[60:63]
    v_mfma_f32_16x16x32_bf16 v[64:67], a[100:103], v[80:83], v[64:67]
    v_mfma_f32_16x16x32_bf16 v[68:71], a[100:103], v[84:87], v[68:71]
    v_mfma_f32_16x16x32_bf16 v[72:75], a[100:103], v[88:91], v[72:75]
    v_mfma_f32_16x16x32_bf16 v[76:79], a[100:103], v[92:95], v[76:79]
    s_waitcnt lgkmcnt(0)
    v_mfma_f32_16x16x32_bf16 v[48:51], a[104:107], v[96:99], v[48:51]
    v_mfma_f32_16x16x32_bf16 v[52:55], a[104:107], v[100:103], v[52:55]
    v_mfma_f32_16x16x32_bf16 v[56:59], a[104:107], v[104:107], v[56:59]
    v_mfma_f32_16x16x32_bf16 v[60:63], a[104:107], v[108:111], v[60:63]
    v_mfma_f32_16x16x32_bf16 v[64:67], a[108:111], v[96:99], v[64:67]
    v_mfma_f32_16x16x32_bf16 v[68:71], a[108:111], v[100:103], v[68:71]
    v_mfma_f32_16x16x32_bf16 v[72:75], a[108:111], v[104:107], v[72:75]
    v_mfma_f32_16x16x32_bf16 v[76:79], a[108:111], v[108:111], v[76:79]
    s_lshl_b32 s39, s44, 13
    s_lshl_b32 s38, s45, 11
    s_add_u32 s39, s39, s38
    s_add_u32 s39, s39, 98304
    v_add_u32 v13, s39, v6
    s_lshl_b32 s39, s45, 14
    s_lshl_b32 s38, s44, 13
    s_add_u32 s39, s39, s38
    s_add_u32 s39, s39, 98304
    v_add_u32 v14, s39, v6
    ds_write_b128 v13, v[48:51] offset:0
    ds_write_b128 v13, v[64:67] offset:1024
    ds_write_b128 v13, v[52:55] offset:16384
    ds_write_b128 v13, v[68:71] offset:17408
    ds_write_b128 v13, v[56:59] offset:32768
    ds_write_b128 v13, v[72:75] offset:33792
    ds_write_b128 v13, v[60:63] offset:49152
    ds_write_b128 v13, v[76:79] offset:50176
    s_waitcnt lgkmcnt(0)
    s_barrier
    ds_read_b128 v[80:83], v14 offset:0
    ds_read_b128 v[84:87], v14 offset:1024
    ds_read_b128 v[88:91], v14 offset:2048
    ds_read_b128 v[92:95], v14 offset:3072
    ds_read_b128 v[96:99], v14 offset:4096
    ds_read_b128 v[100:103], v14 offset:5120
    ds_read_b128 v[104:107], v14 offset:6144
    ds_read_b128 v[108:111], v14 offset:7168
    s_waitcnt vmcnt(0) lgkmcnt(0)
    v_pk_add_f32 v[80:81], v[80:81], v[88:89]
    v_pk_add_f32 v[96:97], v[96:97], v[104:105]
    v_pk_add_f32 v[80:81], v[80:81], v[96:97]
    v_pk_add_f32 v[82:83], v[82:83], v[90:91]
    v_pk_add_f32 v[98:99], v[98:99], v[106:107]
    v_pk_add_f32 v[82:83], v[82:83], v[98:99]
    v_pk_add_f32 v[84:85], v[84:85], v[92:93]
    v_pk_add_f32 v[100:101], v[100:101], v[108:109]
    v_pk_add_f32 v[84:85], v[84:85], v[100:101]
    v_pk_add_f32 v[86:87], v[86:87], v[94:95]
    v_pk_add_f32 v[102:103], v[102:103], v[110:111]
    v_pk_add_f32 v[86:87], v[86:87], v[102:103]
    v_lshlrev_b32 v36, 16, v28
    v_and_b32 v37, 0xffff0000, v28
    v_lshlrev_b32 v38, 16, v29
    v_and_b32 v39, 0xffff0000, v29
    v_fmac_f32 v36, v20, v80
    v_fmac_f32 v37, v21, v81
    v_fmac_f32 v38, v22, v82
    v_fmac_f32 v39, v23, v83
    v_cvt_pk_bf16_f32 v28, v36, v37
    v_cvt_pk_bf16_f32 v29, v38, v39
    v_lshlrev_b32 v36, 16, v30
    v_and_b32 v37, 0xffff0000, v30
    v_lshlrev_b32 v38, 16, v31
    v_and_b32 v39, 0xffff0000, v31
    v_fmac_f32 v36, v24, v84
    v_fmac_f32 v37, v25, v85
    v_fmac_f32 v38, v26, v86
    v_fmac_f32 v39, v27, v87
    v_cvt_pk_bf16_f32 v30, v36, v37
    v_cvt_pk_bf16_f32 v31, v38, v39
    s_nop 1
    v_permlane16_swap_b32 v28, v30
    v_permlane16_swap_b32 v29, v31
    buffer_store_dwordx4 v[28:31], v11, s[24:27], 0 offen
L_k6_kernel_exit:
    s_endpgm
.section .rodata,"a"
.p2align 6
.amdhsa_kernel k1_kernel
  .amdhsa_next_free_vgpr 96
  .amdhsa_next_free_sgpr 102
  .amdhsa_accum_offset 96
  .amdhsa_group_segment_fixed_size 0
  .amdhsa_kernarg_size 88
  .amdhsa_user_sgpr_count 2
  .amdhsa_user_sgpr_kernarg_segment_ptr 1
  .amdhsa_system_sgpr_workgroup_id_x 1
.end_amdhsa_kernel
.p2align 6
.amdhsa_kernel k2_kernel
  .amdhsa_next_free_vgpr 224
  .amdhsa_next_free_sgpr 102
  .amdhsa_accum_offset 112
  .amdhsa_group_segment_fixed_size 0
  .amdhsa_kernarg_size 88
  .amdhsa_user_sgpr_count 2
  .amdhsa_user_sgpr_kernarg_segment_ptr 1
  .amdhsa_system_sgpr_workgroup_id_x 1
.end_amdhsa_kernel
.p2align 6
.amdhsa_kernel k3_kernel
  .amdhsa_next_free_vgpr 248
  .amdhsa_next_free_sgpr 102
  .amdhsa_accum_offset 176
  .amdhsa_group_segment_fixed_size 0
  .amdhsa_kernarg_size 88
  .amdhsa_user_sgpr_count 2
  .amdhsa_user_sgpr_kernarg_segment_ptr 1
  .amdhsa_system_sgpr_workgroup_id_x 1
.end_amdhsa_kernel
.p2align 6
.amdhsa_kernel k4_kernel
  .amdhsa_next_free_vgpr 160
  .amdhsa_next_free_sgpr 102
  .amdhsa_accum_offset 128
  .amdhsa_group_segment_fixed_size 0
  .amdhsa_kernarg_size 88
  .amdhsa_user_sgpr_count 2
  .amdhsa_user_sgpr_kernarg_segment_ptr 1
  .amdhsa_system_sgpr_workgroup_id_x 1
.end_amdhsa_kernel
.p2align 6
.amdhsa_kernel k5_kernel
  .amdhsa_next_free_vgpr 248
  .amdhsa_next_free_sgpr 102
  .amdhsa_accum_offset 136
  .amdhsa_group_segment_fixed_size 0
  .amdhsa_kernarg_size 88
  .amdhsa_user_sgpr_count 2
  .amdhsa_user_sgpr_kernarg_segment_ptr 1
  .amdhsa_system_sgpr_workgroup_id_x 1
.end_amdhsa_kernel
.p2align 6
.amdhsa_kernel k6_kernel
  .amdhsa_next_free_vgpr 240
  .amdhsa_next_free_sgpr 102
  .amdhsa_accum_offset 128
  .amdhsa_group_segment_fixed_size 0
  .amdhsa_kernarg_size 88
  .amdhsa_user_sgpr_count 2
  .amdhsa_user_sgpr_kernarg_segment_ptr 1
  .amdhsa_system_sgpr_workgroup_id_x 1
.end_amdhsa_kernel
```
